```python
import torch

def _softmax(x, axis=-1):
    return torch.softmax(x, dim=axis)
def _gelu(x):
    return torch.nn.functional.gelu(x, approximate="tanh")
def _silu(x):
    return torch.nn.functional.silu(x)
def _sigmoid(x):
    return torch.sigmoid(x)
def _layernorm(x, axis=-1, eps=1e-5):
    m = x.mean(dim=axis, keepdim=True)
    v = x.var(dim=axis, keepdim=True, unbiased=False)
    return (x - m) / torch.sqrt(v + eps)
def _scatter_add(tgt, idx, src, axis=0):
    return tgt.clone().index_add_(axis, idx, src)
def _segment_sum(src, seg, n):
    out = torch.zeros((n,) + src.shape[1:], dtype=src.dtype)
    return out.index_add_(0, seg, src)
def _pad(x, pw):
    flat = tuple(v for pair in reversed(pw) for v in pair)
    return torch.nn.functional.pad(x, flat)

kernel_name = 'standalone__self_sup_conv_stem_hubert__speech'

def setup_inputs():

    _w = (lambda a: (lambda t: t.to(torch.bfloat16) if t.is_floating_point() else t)(torch.as_tensor(a)))
    B, T, D, K = 2, 16000, 144, 31
    scale = (1.0 / (K * D)) ** 0.5
    return {
        "x": _w((lambda *s: torch.randn(*s, dtype=torch.bfloat16) * 0.05)(B, T, D)),
        "w": _w((lambda *s: torch.randn(*s, dtype=torch.bfloat16) * 0.05)(K, D, D) * scale),
        "b": _w((lambda *s: torch.randn(*s, dtype=torch.bfloat16) * 0.05)(D) * 0.1),
        "gamma": _w(torch.ones((D,), dtype=float)),
        "beta": _w(torch.zeros((D,), dtype=float)),
    }

def reference(x, w, b, gamma, beta):
    B, T, D = x.shape
    K = w.shape[0]
    s = 2
    L = (T - K) // s + 1
    y = torch.einsum('blc,cd->bld', x[:, 0 : s * L : s, :], w[0])
    for i in range(1, K):
        y = y + torch.einsum('blc,cd->bld', x[:, i : i + s * L : s, :], w[i])
    y = y + b[None, None, :]
    mu = y.mean(1, keepdims=True)
    var = ((y - mu) ** 2).mean(1, keepdims=True)
    yn = (y - mu) / torch.sqrt(var + 1e-5)
    yn = yn * gamma[None, None, :] + beta[None, None, :]
    return _gelu(yn)
```

```asm
; @launch grid=(256,1,1) block=(512,1,1) lds=163840
.amdgcn_target "amdgcn-amd-amdhsa--gfx950"
.text
.globl standalone__self_sup_conv_stem_hubert__speech_kernel
.p2align 12
.p2align 8
.type standalone__self_sup_conv_stem_hubert__speech_kernel,@function
standalone__self_sup_conv_stem_hubert__speech_kernel:
    s_load_dwordx16 s[4:19], s[0:1], 0
    v_lshrrev_b32 v1, 6, v0
    s_and_b32 s3, s2, 7
    s_lshr_b32 s44, s2, 3
    v_readfirstlane_b32 s40, v1
    s_cmp_ge_u32 s44, 32
    s_cbranch_scc1 L_end
    v_and_b32 v9, 63, v0
    s_mov_b32 s81, s44
    s_mov_b32 s80, 0
    s_lshr_b32 s48, s3, 1
    s_and_b32 s3, s3, 1
    s_lshl_b32 s3, s3, 5
    s_add_u32 s44, s44, s3
    s_cmp_eq_u32 s44, 63
    s_cbranch_scc1 L_idle
    s_mul_i32 s3, s48, 63
    s_add_u32 s44, s44, s3
    s_cmp_lg_u32 s40, 4
    s_cbranch_scc1 L_notouch
    s_getpc_b64 s[88:89]
L_pcref0:
    s_sub_u32 s88, s88, L_pcref0-standalone__self_sup_conv_stem_hubert__speech_kernel
    s_subb_u32 s89, s89, 0
    v_lshl_add_u32 v7, v9, 5, s81
    v_lshlrev_b32 v7, 7, v7
    v_min_u32 v7, L_codeend-standalone__self_sup_conv_stem_hubert__speech_kernel-4, v7
    global_load_dword v13, v7, s[88:89]
    s_cmp_eq_u32 0, 0
    s_call_b64 s[78:79], L_pad_m0
    s_cmp_eq_u32 0, 1
    s_cmp_eq_u32 0, 0
    s_call_b64 s[78:79], L_pad_l0
    s_cmp_eq_u32 0, 1
L_notouch:
    s_mul_hi_u32 s43, s44, 0x55555556
    v_lshrrev_b32 v15, 3, v9
    s_mul_i32 s3, s43, 3
    v_and_b32 v16, 6, v15
    s_sub_u32 s41, s44, s3
    v_and_b32 v14, 7, v9
    s_cmp_ge_u32 s43, 42
    s_cselect_b32 s42, 1, 0
    s_cselect_b32 s3, 42, 0
    s_cselect_b32 s45, 4608000, 0
    v_xor_b32 v14, v14, v16
    s_sub_u32 s43, s43, s3
    v_mul_u32_u24 v15, 1152, v15
    s_mul_i32 s46, s43, 110592
    v_lshl_add_u32 v1, v14, 4, v15
    s_add_u32 s45, s45, s46
    s_sub_u32 s22, 4607712, s46
    s_mov_b32 s23, 0x20000
    s_mov_b32 s26, 1285632
    s_mov_b32 s27, 0x20000
    s_cmp_eq_u32 s41, 1
    s_cselect_b32 s53, -1, 1
    s_cselect_b32 s52, 12, 0
    s_cmp_gt_u32 s40, 4
    s_cbranch_scc1 L_wstart
    s_cmp_eq_u32 s40, 4
    s_cbranch_scc1 L_xstart
    s_and_b32 s46, s40, 1
    s_lshr_b32 s47, s40, 1
    s_mul_i32 s49, s47, s53
    s_add_u32 s49, s49, s52
    s_mul_i32 s52, s53, 18432
    s_lshl_b32 s53, s53, 11
    s_mul_i32 s50, s49, 9216
    s_mul_i32 s3, s46, 13312
    s_lshl_b32 s49, s49, 10
    s_add_u32 s3, s3, s49
    s_add_u32 m0, s3, 256
    s_lshl_b32 s3, s46, 9
    s_sub_u32 s50, s50, s3
    s_addk_i32 s50, 512
    s_mul_i32 s3, s44, 14
    v_min_u32 v10, 13, v9
    v_add_u32 v10, s3, v10
    v_min_u32 v10, 3311, v10
    v_mul_u32_u24 v11, 58255, v10
    v_lshrrev_b32 v11, 22, v11
    v_mul_u32_u24 v12, 72, v11
    v_sub_u32 v10, v10, v12
    v_add_u32 v11, 2, v11
    v_lshrrev_b32 v12, 4, v11
    v_bfe_u32 v14, v11, 1, 3
    v_and_b32 v11, 1, v11
    v_lshl_add_u32 v14, v11, 3, v14
    v_mad_u32_u24 v12, v14, 9, v12
    v_mul_u32_u24 v12, 72, v12
    v_add_lshl_u32 v10, v12, v10, 7
    v_lshrrev_b32 v13, 4, v9
    v_and_b32 v12, 15, v9
    v_mul_u32_u24 v13, 144, v13
    s_mul_i32 s3, s41, 48
    v_add3_u32 v13, v13, v12, s3
    v_lshlrev_b32 v13, 1, v13
    s_mul_i32 s54, s46, 55296
    s_waitcnt lgkmcnt(0)
    s_add_u32 s20, s4, s45
    s_addc_u32 s21, s5, 0
    s_mov_b64 s[24:25], s[6:7]
    s_cmp_lg_u32 s40, 3
    s_cbranch_scc1 L_norawpf
    buffer_load_dword v17, v10, s[24:27], 0 offen
L_norawpf:
    buffer_load_dwordx4 v1, s[20:23], s50 offen lds
    s_add_u32 m0, m0, s53
    s_add_u32 s50, s50, s52
    buffer_load_dwordx4 v1, s[20:23], s50 offen lds
    buffer_load_dwordx4 v[220:223], v1, s[20:23], s54 offen
    buffer_load_ushort v224, v13, s[24:27], 0 offen offset:0
    buffer_load_ushort v225, v13, s[24:27], 0 offen offset:32
    buffer_load_ushort v226, v13, s[24:27], 0 offen offset:64
    s_add_u32 m0, m0, s53
    s_add_u32 s50, s50, s52
    buffer_load_dwordx4 v1, s[20:23], s50 offen lds
    s_add_u32 m0, m0, s53
    s_add_u32 s50, s50, s52
    buffer_load_dwordx4 v1, s[20:23], s50 offen lds
    s_add_u32 m0, m0, s53
    s_add_u32 s50, s50, s52
    buffer_load_dwordx4 v1, s[20:23], s50 offen lds
    v_lshrrev_b32 v14, 3, v9
    v_and_b32 v15, 7, v9
    s_mul_i32 s3, s40, 6912
    s_mul_i32 s49, s41, 96
    s_add_u32 s3, s3, s49
    v_mad_u32_u24 v14, v14, 8, v15
    v_mul_u32_u24 v4, 24, v14
    v_mul_u32_u24 v14, 36, v14
    v_mul_u32_u24 v15, 24, v15
    v_sub_u32 v14, v14, v15
    v_add_u32 v3, s3, v14
    s_mul_i32 s3, s40, 4672
    v_add_u32 v4, s3, v4
    s_mov_b32 s3, 160000
    v_lshl_add_u32 v8, v15, 1, s3
    s_mul_i32 s3, s42, 7985
    s_mul_i32 s49, s43, 192
    s_add_u32 s3, s3, s49
    s_mul_i32 s3, s3, 288
    s_sub_u32 s49, 7985, s49
    s_mul_i32 s30, s49, 288
    s_add_u32 s28, s14, s3
    s_addc_u32 s29, s15, 0
    s_mov_b32 s31, 0x20000
    s_mov_b64 s[32:33], s[18:19]
    s_mov_b32 s34, 0x10000000
    s_mov_b32 s35, 0x20000
    v_and_b32 v12, 15, v9
    v_lshrrev_b32 v13, 4, v9
    v_mul_u32_u24 v10, 3, v12
    s_mul_i32 s45, s46, 96
    v_lshl_add_u32 v14, v10, 1, s45
    v_cmp_le_u32 vcc, s49, v14
    s_mul_i32 s3, s46, 6144
    s_lshl_b32 s53, s47, 9
    s_add_u32 s3, s3, s53
    v_lshl_add_u32 v11, v10, 7, s3
    v_mov_b32 v14, 262144
    v_cndmask_b32 v11, v11, v14, vcc
    s_lshl_b32 s3, s47, 2
    v_xor_b32 v15, s3, v13
    v_add_u32 v16, 0, v10
    v_and_b32 v16, 6, v16
    v_xor_b32 v16, v16, v15
    v_lshl_add_u32 v152, v16, 4, v11
    v_xor_b32 v156, 64, v152
    v_add_u32 v16, 1, v10
    v_and_b32 v16, 6, v16
    v_xor_b32 v16, v16, v15
    v_lshl_add_u32 v153, v16, 4, v11
    v_xor_b32 v157, 64, v153
    v_add_u32 v16, 2, v10
    v_and_b32 v16, 6, v16
    v_xor_b32 v16, v16, v15
    v_lshl_add_u32 v154, v16, 4, v11
    v_xor_b32 v158, 64, v154
    v_add_u32 v16, 3, v10
    v_and_b32 v16, 6, v16
    v_xor_b32 v16, v16, v15
    v_lshl_add_u32 v155, v16, 4, v11
    v_xor_b32 v159, 64, v155
    v_lshrrev_b32 v14, 2, v9
    v_and_b32 v15, 3, v9
    v_mad_u32_u24 v14, v14, 12, v15
    s_mul_i32 s3, s47, 3072
    s_add_u32 s3, s3, 53504
    v_lshl_add_u32 v2, v14, 3, s3
    v_lshl_add_u32 v1, v9, 4, s3
    s_mul_i32 s3, s46, 9216
    s_add_u32 s3, s3, 121088
    v_lshl_add_u32 v5, v9, 4, s3
    s_mul_i32 s3, s47, 3
    s_add_u32 s3, s3, s45
    s_add_u32 s53, s3, 14
    v_mad_u32_u24 v14, v13, 24, s53
    v_cmp_gt_u32 s[54:55], s49, v14
    s_mul_i32 s3, s47, 576
    s_mul_i32 s53, s46, 18688
    s_add_u32 s3, s3, s53
    v_mul_u32_u24 v14, 4672, v13
    v_lshl_add_u32 v14, v12, 2, v14
    v_add_u32 v6, s3, v14
    v_and_b32 v14, 31, v9
    v_lshrrev_b32 v15, 5, v9
    v_lshl_add_u32 v14, v14, 1, v15
    s_lshl_b32 s3, s40, 9
    s_add_u32 s3, s3, 157952
    v_lshl_add_u32 v7, v14, 2, s3
    s_waitcnt vmcnt(3)
    v_and_b32 v220, 0x7fff7fff, v220
    v_and_b32 v221, 0x7fff7fff, v221
    v_and_b32 v222, 0x7fff7fff, v222
    v_and_b32 v223, 0x7fff7fff, v223
    v_and_b32 v224, 0x7fff, v224
    v_and_b32 v225, 0x7fff, v225
    v_and_b32 v226, 0x7fff, v226
    v_pk_max_u16 v220, v220, v221
    v_pk_max_u16 v222, v222, v223
    v_pk_max_u16 v220, v220, v222
    v_mov_b32 v227, v224
    v_mov_b32 v228, v225
    v_mov_b32 v229, v226
    v_permlane32_swap_b32 v224, v227
    v_permlane32_swap_b32 v225, v228
    v_permlane32_swap_b32 v226, v229
    v_max_u32 v224, v224, v227
    v_max_u32 v225, v225, v228
    v_max_u32 v226, v226, v229
    v_mov_b32 v227, v224
    v_mov_b32 v228, v225
    v_mov_b32 v229, v226
    v_permlane16_swap_b32 v224, v227
    v_permlane16_swap_b32 v225, v228
    v_permlane16_swap_b32 v226, v229
    v_max_u32 v224, v224, v227
    v_max_u32 v225, v225, v228
    v_max_u32 v226, v226, v229
    v_lshlrev_b32 v221, 16, v220
    v_max_u32 v220, v220, v221
    v_min_u32 v220, 0x5c000000, v220
    v_mul_f32 v220, 0x43000000, v220
    s_lshl_b32 s3, s47, 31
    s_or_b32 s3, s3, 0x3fc00000
    v_lshlrev_b32 v224, 16, v224
    v_min_u32 v224, 0x5c000000, v224
    v_mul_f32 v224, v224, v220
    v_and_b32 v224, 0x7f800000, v224
    v_mul_f32 v208, s3, v224
    v_mul_f32 v209, s3, v224
    v_mul_f32 v210, s3, v224
    v_mul_f32 v211, s3, v224
    v_lshlrev_b32 v225, 16, v225
    v_min_u32 v225, 0x5c000000, v225
    v_mul_f32 v225, v225, v220
    v_and_b32 v225, 0x7f800000, v225
    v_mul_f32 v212, s3, v225
    v_mul_f32 v213, s3, v225
    v_mul_f32 v214, s3, v225
    v_mul_f32 v215, s3, v225
    v_lshlrev_b32 v226, 16, v226
    v_min_u32 v226, 0x5c000000, v226
    v_mul_f32 v226, v226, v220
    v_and_b32 v226, 0x7f800000, v226
    v_mul_f32 v216, s3, v226
    v_mul_f32 v217, s3, v226
    v_mul_f32 v218, s3, v226
    v_mul_f32 v219, s3, v226
    s_cmp_eq_u32 s47, 1
    s_cselect_b64 vcc, 1, 0
    s_setprio 2
    s_cmp_eq_u32 0, 1
    s_branch L_s_c
L_wstart:
    v_subrev_u32 v10, 320, v0
    s_mul_i32 s3, s41, 6
    v_mul_u32_u24 v15, 171, v10
    v_lshrrev_b32 v15, 10, v15
    v_mul_u32_u24 v16, 6, v15
    v_sub_u32 v14, v10, v16
    v_and_b32 v16, 12, v15
    v_add_u32 v16, v16, v15
    v_lshrrev_b32 v15, 4, v15
    v_mul_u32_u24 v15, 12, v15
    v_sub_u32 v15, v16, v15
    v_mul_u32_u24 v15, 18, v15
    v_add3_u32 v15, v15, v14, s3
    v_lshlrev_b32 v2, 4, v15
    s_lshl_b32 s46, s40, 10
    s_add_u32 s51, s46, 48384
    s_add_u32 s46, s40, 5
    s_mul_i32 s46, s46, s53
    s_add_u32 s46, s46, s52
    s_mul_i32 s47, s46, 9216
    s_lshl_b32 s46, s46, 10
    s_waitcnt lgkmcnt(0)
    s_add_u32 s20, s4, s45
    s_addc_u32 s21, s5, 0
    s_mov_b64 s[24:25], s[6:7]
    s_mov_b32 m0, s51
    s_mov_b32 s50, 0
    buffer_load_dwordx4 v2, s[24:27], s50 offen lds
    s_addk_i32 m0, 3072
    s_mov_b32 s50, 663552
    buffer_load_dwordx4 v2, s[24:27], s50 offen lds
    s_add_u32 m0, s46, 13568
    s_nop 0
    buffer_load_dwordx4 v1, s[20:23], s47 offen lds
    s_addk_i32 m0, -13312
    s_addk_i32 s47, 512
    buffer_load_dwordx4 v1, s[20:23], s47 offen lds
    v_lshrrev_b32 v14, 3, v9
    v_and_b32 v15, 7, v9
    s_mul_i32 s3, s40, 6912
    s_mul_i32 s49, s41, 96
    s_add_u32 s3, s3, s49
    v_mad_u32_u24 v14, v14, 8, v15
    v_mul_u32_u24 v4, 24, v14
    v_mul_u32_u24 v14, 36, v14
    v_mul_u32_u24 v15, 24, v15
    v_sub_u32 v14, v14, v15
    v_add_u32 v3, s3, v14
    s_mul_i32 s3, s40, 4672
    v_add_u32 v4, s3, v4
    s_mov_b32 s3, 160000
    v_lshl_add_u32 v8, v15, 1, s3
    s_mul_i32 s3, s42, 7985
    s_mul_i32 s49, s43, 192
    s_add_u32 s3, s3, s49
    s_mul_i32 s3, s3, 288
    s_sub_u32 s49, 7985, s49
    s_mul_i32 s30, s49, 288
    s_add_u32 s28, s14, s3
    s_addc_u32 s29, s15, 0
    s_mov_b32 s31, 0x20000
    s_mov_b64 s[32:33], s[18:19]
    s_mov_b32 s34, 0x10000000
    s_mov_b32 s35, 0x20000
    s_mul_i32 s3, s42, 3
    s_add_u32 s46, s3, s41
    s_mul_i32 s47, s46, 22528
    s_sub_u32 s45, s40, 5
    v_lshlrev_b32 v12, 4, v10
    s_mul_i32 s3, s41, 442368
    s_add_u32 s3, s3, 262144
    s_add_u32 s56, s18, s3
    s_addc_u32 s57, s19, 0
    s_mov_b32 s58, 442368
    s_mov_b32 s59, 0x20000
    s_add_u32 m0, s51, 6144
    s_mov_b32 s50, 82944
    buffer_load_dwordx4 v2, s[24:27], s50 offen lds
    s_addk_i32 m0, 3072
    s_mov_b32 s50, 746496
    buffer_load_dwordx4 v2, s[24:27], s50 offen lds
    s_addk_i32 m0, 3072
    s_mov_b32 s50, 165888
    buffer_load_dwordx4 v2, s[24:27], s50 offen lds
    s_addk_i32 m0, 3072
    s_mov_b32 s50, 829440
    buffer_load_dwordx4 v2, s[24:27], s50 offen lds
    s_addk_i32 m0, 3072
    s_mov_b32 s50, 248832
    buffer_load_dwordx4 v2, s[24:27], s50 offen lds
    s_addk_i32 m0, 3072
    s_mov_b32 s50, 912384
    buffer_load_dwordx4 v2, s[24:27], s50 offen lds
    s_addk_i32 m0, 3072
    s_mov_b32 s50, 331776
    buffer_load_dwordx4 v2, s[24:27], s50 offen lds
    s_addk_i32 m0, 3072
    s_mov_b32 s50, 995328
    buffer_load_dwordx4 v2, s[24:27], s50 offen lds
    v_and_b32 v15, 3, v9
    v_bfe_u32 v14, v9, 4, 1
    v_lshl_add_u32 v15, v14, 2, v15
    v_lshrrev_b32 v16, 5, v9
    v_bfe_u32 v14, v9, 2, 2
    v_lshl_add_u32 v14, v16, 2, v14
    v_mul_u32_u24 v14, 512, v14
    v_lshl_add_u32 v6, v15, 4, v14
    s_lshl_b32 s3, s45, 7
    s_add_u32 s82, s47, s3
    s_add_u32 s83, s82, 4096
    s_add_u32 s84, s82, 8192
    s_add_u32 s85, s82, 12288
    s_add_u32 s86, s82, 16384
    s_add_u32 s87, s82, 20480
    v_mov_b32 v36, 0
    v_mov_b32 v37, 0
    v_mov_b32 v38, 0
    v_mov_b32 v39, 0
    s_lshl_b32 s3, s45, 4
    v_lshl_add_u32 v15, v15, 1, v16
    v_add_u32 v15, s3, v15
    s_mul_i32 s3, s41, 96
    v_lshl_add_u32 v5, v15, 1, s3
    v_mul_u32_u24 v14, 43, v15
    v_lshrrev_b32 v14, 8, v14
    v_mul_u32_u24 v14, 24, v14
    v_lshl_add_u32 v14, v15, 2, v14
    v_add_u32 v7, 160000, v14
    s_mul_i32 s3, s41, 144
    s_mul_i32 s49, s45, 48
    s_add_u32 s3, s3, s49
    v_mov_b32 v53, 0
    v_mov_b32 v54, 0
    v_mov_b32 v55, 0
    v_mov_b32 v56, 0
    v_mov_b32 v57, 0
    v_mov_b32 v58, 0
    v_mov_b32 v59, 0
    s_mul_i32 s49, s43, 512
    s_add_u32 s47, s47, s49
    v_min_u32 v52, 48, v9
    v_add_lshl_u32 v52, v52, s3, 7
    s_cmp_eq_u32 0, 1
    s_branch L_s_w
L_xstart:
    s_waitcnt lgkmcnt(0)
    s_add_u32 s20, s4, s45
    s_addc_u32 s21, s5, 0
    s_mov_b64 s[24:25], s[6:7]
    v_lshrrev_b32 v14, 3, v9
    v_and_b32 v15, 7, v9
    s_mul_i32 s3, s40, 6912
    s_mul_i32 s49, s41, 96
    s_add_u32 s3, s3, s49
    v_mad_u32_u24 v14, v14, 8, v15
    v_mul_u32_u24 v4, 24, v14
    v_mul_u32_u24 v14, 36, v14
    v_mul_u32_u24 v15, 24, v15
    v_sub_u32 v14, v14, v15
    v_add_u32 v3, s3, v14
    s_mul_i32 s3, s40, 4672
    v_add_u32 v4, s3, v4
    s_mov_b32 s3, 160000
    v_lshl_add_u32 v8, v15, 1, s3
    s_mul_i32 s3, s42, 7985
    s_mul_i32 s49, s43, 192
    s_add_u32 s3, s3, s49
    s_mul_i32 s3, s3, 288
    s_sub_u32 s49, 7985, s49
    s_mul_i32 s30, s49, 288
    s_add_u32 s28, s14, s3
    s_addc_u32 s29, s15, 0
    s_mov_b32 s31, 0x20000
    s_mov_b64 s[32:33], s[18:19]
    s_mov_b32 s34, 0x10000000
    s_mov_b32 s35, 0x20000
    s_mul_i32 s3, s42, 3
    s_add_u32 s46, s3, s41
    s_mul_i32 s47, s46, 22528
    s_mov_b64 s[36:37], s[16:17]
    s_mov_b32 s38, 256
    s_mov_b32 s39, 0x20000
    v_and_b32 v14, 3, v9
    v_lshlrev_b32 v11, 2, v14
    s_getpc_b64 s[88:89]
L_pcref:
    s_sub_u32 s88, s88, L_pcref-standalone__self_sup_conv_stem_hubert__speech_kernel
    s_subb_u32 s89, s89, 0
    v_lshl_add_u32 v7, v9, 5, s81
    v_lshlrev_b32 v7, 7, v7
    v_min_u32 v7, L_codeend-standalone__self_sup_conv_stem_hubert__speech_kernel-4, v7
    v_lshl_add_u32 v12, v9, 9, s47
    v_mov_b32 v24, 1
    s_mul_i32 s3, s43, 512
    s_add_u32 s47, s47, s3
    v_lshlrev_b32 v5, 3, v9
    v_add_u32 v6, 157952, v5
    s_cmp_eq_u32 0, 1
    s_branch L_s_x
L_ret:
    s_setpc_b64 s[78:79]
.p2align 12
L_s_c:
L_pad_m0:
    s_cbranch_scc1 L_ret
    s_waitcnt vmcnt(0) lgkmcnt(0)
    s_barrier
    ds_read_b64_tr_b16 v[88:89], v2 offset:0
    ds_read_b64_tr_b16 v[90:91], v2 offset:1536
    ds_read_b128 v[100:103], v152 offset:13568
    ds_read_b128 v[104:107], v156 offset:256
    ds_read_b128 v[108:111], v153 offset:13696
    ds_read_b128 v[112:115], v157 offset:384
    ds_read_b128 v[116:119], v154 offset:13824
    ds_read_b128 v[120:123], v158 offset:512
    ds_read_b64_tr_b16 v[92:93], v2 offset:32
    ds_read_b64_tr_b16 v[94:95], v2 offset:1568
    s_waitcnt lgkmcnt(7)
    v_mfma_f32_16x16x32_bf16 v[16:19], v[100:103], v[88:91], v[208:211]
    ds_read_b64_tr_b16 v[96:97], v2 offset:64
    s_waitcnt lgkmcnt(7)
    v_mfma_f32_16x16x32_bf16 v[28:31], v[104:107], v[88:91], v[208:211]
    ds_read_b64_tr_b16 v[98:99], v2 offset:1600
    s_waitcnt lgkmcnt(7)
    v_mfma_f32_16x16x32_bf16 v[40:43], v[108:111], v[88:91], v[208:211]
    s_waitcnt lgkmcnt(6)
    v_mfma_f32_16x16x32_bf16 v[52:55], v[112:115], v[88:91], v[208:211]
    s_waitcnt lgkmcnt(5)
    v_mfma_f32_16x16x32_bf16 v[64:67], v[116:119], v[88:91], v[208:211]
    s_waitcnt lgkmcnt(4)
    v_mfma_f32_16x16x32_bf16 v[76:79], v[120:123], v[88:91], v[208:211]
    s_barrier
    s_waitcnt lgkmcnt(2)
    v_mfma_f32_16x16x32_bf16 v[80:83], v[120:123], v[92:95], v[212:215]
    ds_read_b64_tr_b16 v[88:89], v2 offset:6144
    v_mfma_f32_16x16x32_bf16 v[68:71], v[116:119], v[92:95], v[212:215]
    ds_read_b64_tr_b16 v[90:91], v2 offset:7680
    v_mfma_f32_16x16x32_bf16 v[56:59], v[112:115], v[92:95], v[212:215]
    v_mfma_f32_16x16x32_bf16 v[44:47], v[108:111], v[92:95], v[212:215]
    v_mfma_f32_16x16x32_bf16 v[32:35], v[104:107], v[92:95], v[212:215]
    ds_read_b128 v[124:127], v155 offset:13952
    v_mfma_f32_16x16x32_bf16 v[20:23], v[100:103], v[92:95], v[212:215]
    s_waitcnt lgkmcnt(3)
    v_mfma_f32_16x16x32_bf16 v[24:27], v[100:103], v[96:99], v[216:219]
    ds_read_b64_tr_b16 v[92:93], v2 offset:6176
    v_mfma_f32_16x16x32_bf16 v[36:39], v[104:107], v[96:99], v[216:219]
    ds_read_b64_tr_b16 v[94:95], v2 offset:7712
    v_mfma_f32_16x16x32_bf16 v[48:51], v[108:111], v[96:99], v[216:219]
    v_mfma_f32_16x16x32_bf16 v[60:63], v[112:115], v[96:99], v[216:219]
    v_mfma_f32_16x16x32_bf16 v[72:75], v[116:119], v[96:99], v[216:219]
    v_mfma_f32_16x16x32_bf16 v[84:87], v[120:123], v[96:99], v[216:219]
    s_waitcnt lgkmcnt(3)
    v_mfma_f32_16x16x32_bf16 v[16:19], v[104:107], v[88:91], v[16:19]
    ds_read_b64_tr_b16 v[96:97], v2 offset:6208
    v_mfma_f32_16x16x32_bf16 v[28:31], v[108:111], v[88:91], v[28:31]
    ds_read_b64_tr_b16 v[98:99], v2 offset:7744
    v_mfma_f32_16x16x32_bf16 v[40:43], v[112:115], v[88:91], v[40:43]
    v_mfma_f32_16x16x32_bf16 v[52:55], v[116:119], v[88:91], v[52:55]
    v_mfma_f32_16x16x32_bf16 v[64:67], v[120:123], v[88:91], v[64:67]
    s_waitcnt lgkmcnt(4)
    v_mfma_f32_16x16x32_bf16 v[76:79], v[124:127], v[88:91], v[76:79]
    s_barrier
    s_waitcnt lgkmcnt(2)
    v_mfma_f32_16x16x32_bf16 v[80:83], v[124:127], v[92:95], v[80:83]
    ds_read_b64_tr_b16 v[88:89], v2 offset:12288
    v_mfma_f32_16x16x32_bf16 v[68:71], v[120:123], v[92:95], v[68:71]
    ds_read_b64_tr_b16 v[90:91], v2 offset:13824
    v_mfma_f32_16x16x32_bf16 v[56:59], v[116:119], v[92:95], v[56:59]
    ds_read_b64_tr_b16 v[160:161], v2 offset:18432
    v_mfma_f32_16x16x32_bf16 v[44:47], v[112:115], v[92:95], v[44:47]
    ds_read_b64_tr_b16 v[162:163], v2 offset:19968
    v_mfma_f32_16x16x32_bf16 v[32:35], v[108:111], v[92:95], v[32:35]
    v_mfma_f32_16x16x32_bf16 v[20:23], v[104:107], v[92:95], v[20:23]
    s_waitcnt lgkmcnt(4)
    v_mfma_f32_16x16x32_bf16 v[24:27], v[104:107], v[96:99], v[24:27]
    v_mfma_f32_16x16x32_bf16 v[36:39], v[108:111], v[96:99], v[36:39]
    v_mfma_f32_16x16x32_bf16 v[48:51], v[112:115], v[96:99], v[48:51]
    ds_read_b128 v[128:131], v159 offset:640
    v_mfma_f32_16x16x32_bf16 v[60:63], v[116:119], v[96:99], v[60:63]
    v_mfma_f32_16x16x32_bf16 v[72:75], v[120:123], v[96:99], v[72:75]
    ds_read_b128 v[132:135], v156 offset:14080
    v_mfma_f32_16x16x32_bf16 v[84:87], v[124:127], v[96:99], v[84:87]
    ds_read_b64_tr_b16 v[164:165], v2 offset:18464
    s_waitcnt lgkmcnt(3)
    v_mfma_f32_16x16x32_bf16 v[16:19], v[108:111], v[88:91], v[16:19]
    ds_read_b64_tr_b16 v[166:167], v2 offset:20000
    v_mfma_f32_16x16x32_bf16 v[16:19], v[112:115], v[160:163], v[16:19]
    v_mfma_f32_16x16x32_bf16 v[28:31], v[112:115], v[88:91], v[28:31]
    ds_read_b64_tr_b16 v[92:93], v2 offset:12320
    v_mfma_f32_16x16x32_bf16 v[28:31], v[116:119], v[160:163], v[28:31]
    v_mfma_f32_16x16x32_bf16 v[40:43], v[116:119], v[88:91], v[40:43]
    ds_read_b64_tr_b16 v[94:95], v2 offset:13856
    v_mfma_f32_16x16x32_bf16 v[40:43], v[120:123], v[160:163], v[40:43]
    s_barrier
    v_mfma_f32_16x16x32_bf16 v[52:55], v[120:123], v[88:91], v[52:55]
    v_mfma_f32_16x16x32_bf16 v[52:55], v[124:127], v[160:163], v[52:55]
    s_waitcnt lgkmcnt(5)
    v_mfma_f32_16x16x32_bf16 v[64:67], v[124:127], v[88:91], v[64:67]
    v_mfma_f32_16x16x32_bf16 v[64:67], v[128:131], v[160:163], v[64:67]
    s_waitcnt lgkmcnt(4)
    v_mfma_f32_16x16x32_bf16 v[76:79], v[128:131], v[88:91], v[76:79]
    v_mfma_f32_16x16x32_bf16 v[76:79], v[132:135], v[160:163], v[76:79]
    s_waitcnt lgkmcnt(0)
    v_mfma_f32_16x16x32_bf16 v[80:83], v[132:135], v[164:167], v[80:83]
    ds_read_b64_tr_b16 v[96:97], v2 offset:12352
    v_mfma_f32_16x16x32_bf16 v[80:83], v[128:131], v[92:95], v[80:83]
    v_mfma_f32_16x16x32_bf16 v[68:71], v[128:131], v[164:167], v[68:71]
    ds_read_b64_tr_b16 v[98:99], v2 offset:13888
    v_mfma_f32_16x16x32_bf16 v[68:71], v[124:127], v[92:95], v[68:71]
    v_mfma_f32_16x16x32_bf16 v[56:59], v[124:127], v[164:167], v[56:59]
    ds_read_b64_tr_b16 v[168:169], v2 offset:18496
    v_mfma_f32_16x16x32_bf16 v[56:59], v[120:123], v[92:95], v[56:59]
    v_mfma_f32_16x16x32_bf16 v[44:47], v[120:123], v[164:167], v[44:47]
    ds_read_b64_tr_b16 v[170:171], v2 offset:20032
    v_mfma_f32_16x16x32_bf16 v[44:47], v[116:119], v[92:95], v[44:47]
    v_mfma_f32_16x16x32_bf16 v[32:35], v[116:119], v[164:167], v[32:35]
    v_mfma_f32_16x16x32_bf16 v[32:35], v[112:115], v[92:95], v[32:35]
    v_mfma_f32_16x16x32_bf16 v[20:23], v[112:115], v[164:167], v[20:23]
    v_mfma_f32_16x16x32_bf16 v[20:23], v[108:111], v[92:95], v[20:23]
    s_barrier
    s_waitcnt lgkmcnt(0)
    v_mfma_f32_16x16x32_bf16 v[24:27], v[108:111], v[96:99], v[24:27]
    ds_read_b64_tr_b16 v[88:89], v2 offset:24576
    v_mfma_f32_16x16x32_bf16 v[24:27], v[112:115], v[168:171], v[24:27]
    v_mfma_f32_16x16x32_bf16 v[36:39], v[112:115], v[96:99], v[36:39]
    ds_read_b64_tr_b16 v[90:91], v2 offset:26112
    v_mfma_f32_16x16x32_bf16 v[36:39], v[116:119], v[168:171], v[36:39]
    v_mfma_f32_16x16x32_bf16 v[48:51], v[116:119], v[96:99], v[48:51]
    ds_read_b64_tr_b16 v[160:161], v2 offset:30720
    v_mfma_f32_16x16x32_bf16 v[48:51], v[120:123], v[168:171], v[48:51]
    v_mfma_f32_16x16x32_bf16 v[60:63], v[120:123], v[96:99], v[60:63]
    ds_read_b64_tr_b16 v[162:163], v2 offset:32256
    v_mfma_f32_16x16x32_bf16 v[60:63], v[124:127], v[168:171], v[60:63]
    v_mfma_f32_16x16x32_bf16 v[72:75], v[124:127], v[96:99], v[72:75]
    ds_read_b128 v[136:139], v152 offset:768
    v_mfma_f32_16x16x32_bf16 v[72:75], v[128:131], v[168:171], v[72:75]
    v_mfma_f32_16x16x32_bf16 v[84:87], v[128:131], v[96:99], v[84:87]
    ds_read_b128 v[140:143], v157 offset:14208
    v_mfma_f32_16x16x32_bf16 v[84:87], v[132:135], v[168:171], v[84:87]
    s_waitcnt lgkmcnt(2)
    v_mfma_f32_16x16x32_bf16 v[16:19], v[116:119], v[88:91], v[16:19]
    ds_read_b64_tr_b16 v[164:165], v2 offset:30752
    v_mfma_f32_16x16x32_bf16 v[16:19], v[120:123], v[160:163], v[16:19]
    v_mfma_f32_16x16x32_bf16 v[28:31], v[120:123], v[88:91], v[28:31]
    ds_read_b64_tr_b16 v[166:167], v2 offset:32288
    v_mfma_f32_16x16x32_bf16 v[28:31], v[124:127], v[160:163], v[28:31]
    v_mfma_f32_16x16x32_bf16 v[40:43], v[124:127], v[88:91], v[40:43]
    ds_read_b64_tr_b16 v[92:93], v2 offset:24608
    v_mfma_f32_16x16x32_bf16 v[40:43], v[128:131], v[160:163], v[40:43]
    s_barrier
    v_mfma_f32_16x16x32_bf16 v[52:55], v[128:131], v[88:91], v[52:55]
    ds_read_b64_tr_b16 v[94:95], v2 offset:26144
    v_mfma_f32_16x16x32_bf16 v[52:55], v[132:135], v[160:163], v[52:55]
    s_waitcnt lgkmcnt(5)
    v_mfma_f32_16x16x32_bf16 v[64:67], v[132:135], v[88:91], v[64:67]
    v_mfma_f32_16x16x32_bf16 v[64:67], v[136:139], v[160:163], v[64:67]
    s_waitcnt lgkmcnt(4)
    v_mfma_f32_16x16x32_bf16 v[76:79], v[136:139], v[88:91], v[76:79]
    v_mfma_f32_16x16x32_bf16 v[76:79], v[140:143], v[160:163], v[76:79]
    s_waitcnt lgkmcnt(0)
    v_mfma_f32_16x16x32_bf16 v[80:83], v[140:143], v[164:167], v[80:83]
    ds_read_b64_tr_b16 v[96:97], v2 offset:24640
    v_mfma_f32_16x16x32_bf16 v[80:83], v[136:139], v[92:95], v[80:83]
    v_mfma_f32_16x16x32_bf16 v[68:71], v[136:139], v[164:167], v[68:71]
    ds_read_b64_tr_b16 v[98:99], v2 offset:26176
    v_mfma_f32_16x16x32_bf16 v[68:71], v[132:135], v[92:95], v[68:71]
    v_mfma_f32_16x16x32_bf16 v[56:59], v[132:135], v[164:167], v[56:59]
    ds_read_b64_tr_b16 v[168:169], v2 offset:30784
    v_mfma_f32_16x16x32_bf16 v[56:59], v[128:131], v[92:95], v[56:59]
    v_mfma_f32_16x16x32_bf16 v[44:47], v[128:131], v[164:167], v[44:47]
    ds_read_b64_tr_b16 v[170:171], v2 offset:32320
    v_mfma_f32_16x16x32_bf16 v[44:47], v[124:127], v[92:95], v[44:47]
    v_mfma_f32_16x16x32_bf16 v[32:35], v[124:127], v[164:167], v[32:35]
    v_mfma_f32_16x16x32_bf16 v[32:35], v[120:123], v[92:95], v[32:35]
    v_mfma_f32_16x16x32_bf16 v[20:23], v[120:123], v[164:167], v[20:23]
    v_mfma_f32_16x16x32_bf16 v[20:23], v[116:119], v[92:95], v[20:23]
    s_barrier
    s_waitcnt lgkmcnt(0)
    v_mfma_f32_16x16x32_bf16 v[24:27], v[116:119], v[96:99], v[24:27]
    ds_read_b64_tr_b16 v[88:89], v2 offset:36864
    v_mfma_f32_16x16x32_bf16 v[24:27], v[120:123], v[168:171], v[24:27]
    v_mfma_f32_16x16x32_bf16 v[36:39], v[120:123], v[96:99], v[36:39]
    ds_read_b64_tr_b16 v[90:91], v2 offset:38400
    v_mfma_f32_16x16x32_bf16 v[36:39], v[124:127], v[168:171], v[36:39]
    v_mfma_f32_16x16x32_bf16 v[48:51], v[124:127], v[96:99], v[48:51]
    ds_read_b64_tr_b16 v[160:161], v2 offset:43008
    v_mfma_f32_16x16x32_bf16 v[48:51], v[128:131], v[168:171], v[48:51]
    v_mfma_f32_16x16x32_bf16 v[60:63], v[128:131], v[96:99], v[60:63]
    ds_read_b64_tr_b16 v[162:163], v2 offset:44544
    v_mfma_f32_16x16x32_bf16 v[60:63], v[132:135], v[168:171], v[60:63]
    v_mfma_f32_16x16x32_bf16 v[72:75], v[132:135], v[96:99], v[72:75]
    ds_read_b128 v[144:147], v153 offset:896
    v_mfma_f32_16x16x32_bf16 v[72:75], v[136:139], v[168:171], v[72:75]
    v_mfma_f32_16x16x32_bf16 v[84:87], v[136:139], v[96:99], v[84:87]
    ds_read_b128 v[148:151], v158 offset:14336
    v_mfma_f32_16x16x32_bf16 v[84:87], v[140:143], v[168:171], v[84:87]
    s_waitcnt lgkmcnt(2)
    v_mfma_f32_16x16x32_bf16 v[16:19], v[124:127], v[88:91], v[16:19]
    ds_read_b64_tr_b16 v[164:165], v2 offset:43040
    v_mfma_f32_16x16x32_bf16 v[16:19], v[128:131], v[160:163], v[16:19]
    v_mfma_f32_16x16x32_bf16 v[28:31], v[128:131], v[88:91], v[28:31]
    ds_read_b64_tr_b16 v[166:167], v2 offset:44576
    v_mfma_f32_16x16x32_bf16 v[28:31], v[132:135], v[160:163], v[28:31]
    v_mfma_f32_16x16x32_bf16 v[40:43], v[132:135], v[88:91], v[40:43]
    ds_read_b64_tr_b16 v[92:93], v2 offset:36896
    v_mfma_f32_16x16x32_bf16 v[40:43], v[136:139], v[160:163], v[40:43]
    s_barrier
    v_mfma_f32_16x16x32_bf16 v[52:55], v[136:139], v[88:91], v[52:55]
    ds_read_b64_tr_b16 v[94:95], v2 offset:38432
    v_mfma_f32_16x16x32_bf16 v[52:55], v[140:143], v[160:163], v[52:55]
    s_waitcnt lgkmcnt(5)
    v_mfma_f32_16x16x32_bf16 v[64:67], v[140:143], v[88:91], v[64:67]
    v_mfma_f32_16x16x32_bf16 v[64:67], v[144:147], v[160:163], v[64:67]
    s_waitcnt lgkmcnt(4)
    v_mfma_f32_16x16x32_bf16 v[76:79], v[144:147], v[88:91], v[76:79]
    v_mfma_f32_16x16x32_bf16 v[76:79], v[148:151], v[160:163], v[76:79]
    s_waitcnt lgkmcnt(0)
    v_mfma_f32_16x16x32_bf16 v[80:83], v[148:151], v[164:167], v[80:83]
    ds_read_b64_tr_b16 v[96:97], v2 offset:36928
    v_mfma_f32_16x16x32_bf16 v[80:83], v[144:147], v[92:95], v[80:83]
    v_mfma_f32_16x16x32_bf16 v[68:71], v[144:147], v[164:167], v[68:71]
    ds_read_b64_tr_b16 v[98:99], v2 offset:38464
    v_mfma_f32_16x16x32_bf16 v[68:71], v[140:143], v[92:95], v[68:71]
    v_mfma_f32_16x16x32_bf16 v[56:59], v[140:143], v[164:167], v[56:59]
    ds_read_b64_tr_b16 v[168:169], v2 offset:43072
    v_mfma_f32_16x16x32_bf16 v[56:59], v[136:139], v[92:95], v[56:59]
    v_mfma_f32_16x16x32_bf16 v[44:47], v[136:139], v[164:167], v[44:47]
    ds_read_b64_tr_b16 v[170:171], v2 offset:44608
    v_mfma_f32_16x16x32_bf16 v[44:47], v[132:135], v[92:95], v[44:47]
    v_mfma_f32_16x16x32_bf16 v[32:35], v[132:135], v[164:167], v[32:35]
    v_mfma_f32_16x16x32_bf16 v[32:35], v[128:131], v[92:95], v[32:35]
    v_mfma_f32_16x16x32_bf16 v[20:23], v[128:131], v[164:167], v[20:23]
    v_mfma_f32_16x16x32_bf16 v[20:23], v[124:127], v[92:95], v[20:23]
    s_barrier
    s_waitcnt lgkmcnt(0)
    v_mfma_f32_16x16x32_bf16 v[24:27], v[124:127], v[96:99], v[24:27]
    ds_read_b64_tr_b16 v[88:89], v2 offset:49152
    v_mfma_f32_16x16x32_bf16 v[24:27], v[128:131], v[168:171], v[24:27]
    v_mfma_f32_16x16x32_bf16 v[36:39], v[128:131], v[96:99], v[36:39]
    ds_read_b64_tr_b16 v[90:91], v2 offset:50688
    v_mfma_f32_16x16x32_bf16 v[36:39], v[132:135], v[168:171], v[36:39]
    v_mfma_f32_16x16x32_bf16 v[48:51], v[132:135], v[96:99], v[48:51]
    ds_read_b128 v[100:103], v156 offset:13568
    v_mfma_f32_16x16x32_bf16 v[48:51], v[136:139], v[168:171], v[48:51]
    v_mfma_f32_16x16x32_bf16 v[60:63], v[136:139], v[96:99], v[60:63]
    ds_read_b64_tr_b16 v[160:161], v2 offset:55296
    v_mfma_f32_16x16x32_bf16 v[60:63], v[140:143], v[168:171], v[60:63]
    ds_read_b64_tr_b16 v[162:163], v2 offset:56832
    v_mfma_f32_16x16x32_bf16 v[72:75], v[140:143], v[96:99], v[72:75]
    ds_read_b128 v[104:107], v152 offset:26880
    v_mfma_f32_16x16x32_bf16 v[72:75], v[144:147], v[168:171], v[72:75]
    ds_read_b128 v[108:111], v157 offset:13696
    v_mfma_f32_16x16x32_bf16 v[84:87], v[144:147], v[96:99], v[84:87]
    ds_read_b128 v[112:115], v153 offset:27008
    v_mfma_f32_16x16x32_bf16 v[84:87], v[148:151], v[168:171], v[84:87]
    s_waitcnt lgkmcnt(2)
    v_mfma_f32_16x16x32_bf16 v[16:19], v[100:103], v[88:91], v[16:19]
    ds_read_b128 v[116:119], v158 offset:13824
    v_mfma_f32_16x16x32_bf16 v[16:19], v[104:107], v[160:163], v[16:19]
    s_waitcnt lgkmcnt(2)
    v_mfma_f32_16x16x32_bf16 v[28:31], v[104:107], v[88:91], v[28:31]
    ds_read_b128 v[120:123], v154 offset:27136
    v_mfma_f32_16x16x32_bf16 v[28:31], v[108:111], v[160:163], v[28:31]
    s_waitcnt lgkmcnt(2)
    v_mfma_f32_16x16x32_bf16 v[40:43], v[108:111], v[88:91], v[40:43]
    ds_read_b128 v[124:127], v159 offset:13952
    v_mfma_f32_16x16x32_bf16 v[40:43], v[112:115], v[160:163], v[40:43]
    s_barrier
    ds_read_b64_tr_b16 v[164:165], v2 offset:55328
    s_waitcnt lgkmcnt(3)
    v_mfma_f32_16x16x32_bf16 v[52:55], v[112:115], v[88:91], v[52:55]
    ds_read_b64_tr_b16 v[166:167], v2 offset:56864
    v_mfma_f32_16x16x32_bf16 v[52:55], v[116:119], v[160:163], v[52:55]
    ds_read_b64_tr_b16 v[92:93], v2 offset:49184
    s_waitcnt lgkmcnt(4)
    v_mfma_f32_16x16x32_bf16 v[64:67], v[116:119], v[88:91], v[64:67]
    ds_read_b64_tr_b16 v[94:95], v2 offset:50720
    v_mfma_f32_16x16x32_bf16 v[64:67], v[120:123], v[160:163], v[64:67]
    s_waitcnt lgkmcnt(4)
    v_mfma_f32_16x16x32_bf16 v[76:79], v[120:123], v[88:91], v[76:79]
    v_mfma_f32_16x16x32_bf16 v[76:79], v[124:127], v[160:163], v[76:79]
    s_waitcnt lgkmcnt(0)
    v_mfma_f32_16x16x32_bf16 v[80:83], v[124:127], v[164:167], v[80:83]
    ds_read_b64_tr_b16 v[96:97], v2 offset:49216
    v_mfma_f32_16x16x32_bf16 v[80:83], v[120:123], v[92:95], v[80:83]
    v_mfma_f32_16x16x32_bf16 v[68:71], v[120:123], v[164:167], v[68:71]
    ds_read_b64_tr_b16 v[98:99], v2 offset:50752
    v_mfma_f32_16x16x32_bf16 v[68:71], v[116:119], v[92:95], v[68:71]
    v_mfma_f32_16x16x32_bf16 v[56:59], v[116:119], v[164:167], v[56:59]
    ds_read_b64_tr_b16 v[168:169], v2 offset:55360
    v_mfma_f32_16x16x32_bf16 v[56:59], v[112:115], v[92:95], v[56:59]
    v_mfma_f32_16x16x32_bf16 v[44:47], v[112:115], v[164:167], v[44:47]
    ds_read_b64_tr_b16 v[170:171], v2 offset:56896
    v_mfma_f32_16x16x32_bf16 v[44:47], v[108:111], v[92:95], v[44:47]
    v_mfma_f32_16x16x32_bf16 v[32:35], v[108:111], v[164:167], v[32:35]
    v_mfma_f32_16x16x32_bf16 v[32:35], v[104:107], v[92:95], v[32:35]
    v_mfma_f32_16x16x32_bf16 v[20:23], v[104:107], v[164:167], v[20:23]
    v_mfma_f32_16x16x32_bf16 v[20:23], v[100:103], v[92:95], v[20:23]
    s_barrier
    s_waitcnt lgkmcnt(0)
    v_mfma_f32_16x16x32_bf16 v[24:27], v[100:103], v[96:99], v[24:27]
    ds_read_b64_tr_b16 v[88:89], v2 offset:61440
    v_mfma_f32_16x16x32_bf16 v[24:27], v[104:107], v[168:171], v[24:27]
    v_mfma_f32_16x16x32_bf16 v[36:39], v[104:107], v[96:99], v[36:39]
    ds_read_b64_tr_b16 v[90:91], v2 offset:62976
    v_mfma_f32_16x16x32_bf16 v[36:39], v[108:111], v[168:171], v[36:39]
    v_mfma_f32_16x16x32_bf16 v[48:51], v[108:111], v[96:99], v[48:51]
    ds_read_b64_tr_b16 v[160:161], v2 offset:0
    v_mfma_f32_16x16x32_bf16 v[48:51], v[112:115], v[168:171], v[48:51]
    v_mfma_f32_16x16x32_bf16 v[60:63], v[112:115], v[96:99], v[60:63]
    ds_read_b64_tr_b16 v[162:163], v2 offset:1536
    v_mfma_f32_16x16x32_bf16 v[60:63], v[116:119], v[168:171], v[60:63]
    v_mfma_f32_16x16x32_bf16 v[72:75], v[116:119], v[96:99], v[72:75]
    ds_read_b128 v[128:131], v155 offset:27264
    v_mfma_f32_16x16x32_bf16 v[72:75], v[120:123], v[168:171], v[72:75]
    v_mfma_f32_16x16x32_bf16 v[84:87], v[120:123], v[96:99], v[84:87]
    ds_read_b128 v[132:135], v152 offset:14080
    v_mfma_f32_16x16x32_bf16 v[84:87], v[124:127], v[168:171], v[84:87]
    s_waitcnt lgkmcnt(2)
    v_mfma_f32_16x16x32_bf16 v[16:19], v[108:111], v[88:91], v[16:19]
    ds_read_b64_tr_b16 v[164:165], v2 offset:32
    v_mfma_f32_16x16x32_bf16 v[16:19], v[112:115], v[160:163], v[16:19]
    v_mfma_f32_16x16x32_bf16 v[28:31], v[112:115], v[88:91], v[28:31]
    ds_read_b64_tr_b16 v[166:167], v2 offset:1568
    v_mfma_f32_16x16x32_bf16 v[28:31], v[116:119], v[160:163], v[28:31]
    v_mfma_f32_16x16x32_bf16 v[40:43], v[116:119], v[88:91], v[40:43]
    ds_read_b64_tr_b16 v[92:93], v2 offset:61472
    v_mfma_f32_16x16x32_bf16 v[40:43], v[120:123], v[160:163], v[40:43]
    s_barrier
    v_mfma_f32_16x16x32_bf16 v[52:55], v[120:123], v[88:91], v[52:55]
    ds_read_b64_tr_b16 v[94:95], v2 offset:63008
    v_mfma_f32_16x16x32_bf16 v[52:55], v[124:127], v[160:163], v[52:55]
    s_waitcnt lgkmcnt(5)
    v_mfma_f32_16x16x32_bf16 v[64:67], v[124:127], v[88:91], v[64:67]
    v_mfma_f32_16x16x32_bf16 v[64:67], v[128:131], v[160:163], v[64:67]
    s_waitcnt lgkmcnt(4)
    v_mfma_f32_16x16x32_bf16 v[76:79], v[128:131], v[88:91], v[76:79]
    v_mfma_f32_16x16x32_bf16 v[76:79], v[132:135], v[160:163], v[76:79]
    s_waitcnt lgkmcnt(0)
    v_mfma_f32_16x16x32_bf16 v[80:83], v[132:135], v[164:167], v[80:83]
    ds_read_b64_tr_b16 v[96:97], v2 offset:61504
    v_mfma_f32_16x16x32_bf16 v[80:83], v[128:131], v[92:95], v[80:83]
    v_mfma_f32_16x16x32_bf16 v[68:71], v[128:131], v[164:167], v[68:71]
    ds_read_b64_tr_b16 v[98:99], v2 offset:63040
    v_mfma_f32_16x16x32_bf16 v[68:71], v[124:127], v[92:95], v[68:71]
    v_mfma_f32_16x16x32_bf16 v[56:59], v[124:127], v[164:167], v[56:59]
    ds_read_b64_tr_b16 v[168:169], v2 offset:64
    v_mfma_f32_16x16x32_bf16 v[56:59], v[120:123], v[92:95], v[56:59]
    v_mfma_f32_16x16x32_bf16 v[44:47], v[120:123], v[164:167], v[44:47]
    ds_read_b64_tr_b16 v[170:171], v2 offset:1600
    v_mfma_f32_16x16x32_bf16 v[44:47], v[116:119], v[92:95], v[44:47]
    v_mfma_f32_16x16x32_bf16 v[32:35], v[116:119], v[164:167], v[32:35]
    v_mfma_f32_16x16x32_bf16 v[32:35], v[112:115], v[92:95], v[32:35]
    v_mfma_f32_16x16x32_bf16 v[20:23], v[112:115], v[164:167], v[20:23]
    v_mfma_f32_16x16x32_bf16 v[20:23], v[108:111], v[92:95], v[20:23]
    s_barrier
    s_waitcnt lgkmcnt(0)
    v_mfma_f32_16x16x32_bf16 v[24:27], v[108:111], v[96:99], v[24:27]
    ds_read_b64_tr_b16 v[88:89], v2 offset:6144
    v_mfma_f32_16x16x32_bf16 v[24:27], v[112:115], v[168:171], v[24:27]
    v_mfma_f32_16x16x32_bf16 v[36:39], v[112:115], v[96:99], v[36:39]
    ds_read_b64_tr_b16 v[90:91], v2 offset:7680
    v_mfma_f32_16x16x32_bf16 v[36:39], v[116:119], v[168:171], v[36:39]
    v_mfma_f32_16x16x32_bf16 v[48:51], v[116:119], v[96:99], v[48:51]
    ds_read_b64_tr_b16 v[160:161], v2 offset:12288
    v_mfma_f32_16x16x32_bf16 v[48:51], v[120:123], v[168:171], v[48:51]
    v_mfma_f32_16x16x32_bf16 v[60:63], v[120:123], v[96:99], v[60:63]
    ds_read_b64_tr_b16 v[162:163], v2 offset:13824
    v_mfma_f32_16x16x32_bf16 v[60:63], v[124:127], v[168:171], v[60:63]
    v_mfma_f32_16x16x32_bf16 v[72:75], v[124:127], v[96:99], v[72:75]
    ds_read_b128 v[136:139], v156 offset:27392
    v_mfma_f32_16x16x32_bf16 v[72:75], v[128:131], v[168:171], v[72:75]
    v_mfma_f32_16x16x32_bf16 v[84:87], v[128:131], v[96:99], v[84:87]
    ds_read_b128 v[140:143], v153 offset:14208
    v_mfma_f32_16x16x32_bf16 v[84:87], v[132:135], v[168:171], v[84:87]
    s_waitcnt lgkmcnt(2)
    v_mfma_f32_16x16x32_bf16 v[16:19], v[116:119], v[88:91], v[16:19]
    ds_read_b64_tr_b16 v[164:165], v2 offset:12320
    v_mfma_f32_16x16x32_bf16 v[16:19], v[120:123], v[160:163], v[16:19]
    v_mfma_f32_16x16x32_bf16 v[28:31], v[120:123], v[88:91], v[28:31]
    ds_read_b64_tr_b16 v[166:167], v2 offset:13856
    v_mfma_f32_16x16x32_bf16 v[28:31], v[124:127], v[160:163], v[28:31]
    v_mfma_f32_16x16x32_bf16 v[40:43], v[124:127], v[88:91], v[40:43]
    ds_read_b64_tr_b16 v[92:93], v2 offset:6176
    v_mfma_f32_16x16x32_bf16 v[40:43], v[128:131], v[160:163], v[40:43]
    s_barrier
    v_mfma_f32_16x16x32_bf16 v[52:55], v[128:131], v[88:91], v[52:55]
    ds_read_b64_tr_b16 v[94:95], v2 offset:7712
    v_mfma_f32_16x16x32_bf16 v[52:55], v[132:135], v[160:163], v[52:55]
    s_waitcnt lgkmcnt(5)
    v_mfma_f32_16x16x32_bf16 v[64:67], v[132:135], v[88:91], v[64:67]
    v_mfma_f32_16x16x32_bf16 v[64:67], v[136:139], v[160:163], v[64:67]
    s_waitcnt lgkmcnt(4)
    v_mfma_f32_16x16x32_bf16 v[76:79], v[136:139], v[88:91], v[76:79]
    v_mfma_f32_16x16x32_bf16 v[76:79], v[140:143], v[160:163], v[76:79]
    s_waitcnt lgkmcnt(0)
    v_mfma_f32_16x16x32_bf16 v[80:83], v[140:143], v[164:167], v[80:83]
    ds_read_b64_tr_b16 v[96:97], v2 offset:6208
    v_mfma_f32_16x16x32_bf16 v[80:83], v[136:139], v[92:95], v[80:83]
    v_mfma_f32_16x16x32_bf16 v[68:71], v[136:139], v[164:167], v[68:71]
    ds_read_b64_tr_b16 v[98:99], v2 offset:7744
    v_mfma_f32_16x16x32_bf16 v[68:71], v[132:135], v[92:95], v[68:71]
    v_mfma_f32_16x16x32_bf16 v[56:59], v[132:135], v[164:167], v[56:59]
    ds_read_b64_tr_b16 v[168:169], v2 offset:12352
    v_mfma_f32_16x16x32_bf16 v[56:59], v[128:131], v[92:95], v[56:59]
    v_mfma_f32_16x16x32_bf16 v[44:47], v[128:131], v[164:167], v[44:47]
    ds_read_b64_tr_b16 v[170:171], v2 offset:13888
    v_mfma_f32_16x16x32_bf16 v[44:47], v[124:127], v[92:95], v[44:47]
    v_mfma_f32_16x16x32_bf16 v[32:35], v[124:127], v[164:167], v[32:35]
    v_mfma_f32_16x16x32_bf16 v[32:35], v[120:123], v[92:95], v[32:35]
    v_mfma_f32_16x16x32_bf16 v[20:23], v[120:123], v[164:167], v[20:23]
    v_mfma_f32_16x16x32_bf16 v[20:23], v[116:119], v[92:95], v[20:23]
    s_barrier
    s_waitcnt lgkmcnt(0)
    v_mfma_f32_16x16x32_bf16 v[24:27], v[116:119], v[96:99], v[24:27]
    ds_read_b64_tr_b16 v[88:89], v2 offset:18432
    v_mfma_f32_16x16x32_bf16 v[24:27], v[120:123], v[168:171], v[24:27]
    v_mfma_f32_16x16x32_bf16 v[36:39], v[120:123], v[96:99], v[36:39]
    ds_read_b64_tr_b16 v[90:91], v2 offset:19968
    v_mfma_f32_16x16x32_bf16 v[36:39], v[124:127], v[168:171], v[36:39]
    v_mfma_f32_16x16x32_bf16 v[48:51], v[124:127], v[96:99], v[48:51]
    ds_read_b64_tr_b16 v[160:161], v2 offset:24576
    v_mfma_f32_16x16x32_bf16 v[48:51], v[128:131], v[168:171], v[48:51]
    v_mfma_f32_16x16x32_bf16 v[60:63], v[128:131], v[96:99], v[60:63]
    ds_read_b64_tr_b16 v[162:163], v2 offset:26112
    v_mfma_f32_16x16x32_bf16 v[60:63], v[132:135], v[168:171], v[60:63]
    v_mfma_f32_16x16x32_bf16 v[72:75], v[132:135], v[96:99], v[72:75]
    ds_read_b128 v[144:147], v157 offset:27520
    v_mfma_f32_16x16x32_bf16 v[72:75], v[136:139], v[168:171], v[72:75]
    v_mfma_f32_16x16x32_bf16 v[84:87], v[136:139], v[96:99], v[84:87]
    ds_read_b128 v[148:151], v154 offset:14336
    v_mfma_f32_16x16x32_bf16 v[84:87], v[140:143], v[168:171], v[84:87]
    s_waitcnt lgkmcnt(2)
    v_mfma_f32_16x16x32_bf16 v[16:19], v[124:127], v[88:91], v[16:19]
    ds_read_b64_tr_b16 v[164:165], v2 offset:24608
    v_mfma_f32_16x16x32_bf16 v[16:19], v[128:131], v[160:163], v[16:19]
    v_mfma_f32_16x16x32_bf16 v[28:31], v[128:131], v[88:91], v[28:31]
    ds_read_b64_tr_b16 v[166:167], v2 offset:26144
    v_mfma_f32_16x16x32_bf16 v[28:31], v[132:135], v[160:163], v[28:31]
    v_mfma_f32_16x16x32_bf16 v[40:43], v[132:135], v[88:91], v[40:43]
    ds_read_b64_tr_b16 v[92:93], v2 offset:18464
    v_mfma_f32_16x16x32_bf16 v[40:43], v[136:139], v[160:163], v[40:43]
    s_barrier
    v_mfma_f32_16x16x32_bf16 v[52:55], v[136:139], v[88:91], v[52:55]
    ds_read_b64_tr_b16 v[94:95], v2 offset:20000
    v_mfma_f32_16x16x32_bf16 v[52:55], v[140:143], v[160:163], v[52:55]
    s_waitcnt lgkmcnt(5)
    v_mfma_f32_16x16x32_bf16 v[64:67], v[140:143], v[88:91], v[64:67]
    v_mfma_f32_16x16x32_bf16 v[64:67], v[144:147], v[160:163], v[64:67]
    s_waitcnt lgkmcnt(4)
    v_mfma_f32_16x16x32_bf16 v[76:79], v[144:147], v[88:91], v[76:79]
    v_mfma_f32_16x16x32_bf16 v[76:79], v[148:151], v[160:163], v[76:79]
    s_waitcnt lgkmcnt(0)
    v_mfma_f32_16x16x32_bf16 v[80:83], v[148:151], v[164:167], v[80:83]
    ds_read_b64_tr_b16 v[96:97], v2 offset:18496
    v_mfma_f32_16x16x32_bf16 v[80:83], v[144:147], v[92:95], v[80:83]
    v_mfma_f32_16x16x32_bf16 v[68:71], v[144:147], v[164:167], v[68:71]
    ds_read_b64_tr_b16 v[98:99], v2 offset:20032
    v_mfma_f32_16x16x32_bf16 v[68:71], v[140:143], v[92:95], v[68:71]
    v_mfma_f32_16x16x32_bf16 v[56:59], v[140:143], v[164:167], v[56:59]
    ds_read_b64_tr_b16 v[168:169], v2 offset:24640
    v_mfma_f32_16x16x32_bf16 v[56:59], v[136:139], v[92:95], v[56:59]
    v_mfma_f32_16x16x32_bf16 v[44:47], v[136:139], v[164:167], v[44:47]
    ds_read_b64_tr_b16 v[170:171], v2 offset:26176
    v_mfma_f32_16x16x32_bf16 v[44:47], v[132:135], v[92:95], v[44:47]
    v_mfma_f32_16x16x32_bf16 v[32:35], v[132:135], v[164:167], v[32:35]
    v_mfma_f32_16x16x32_bf16 v[32:35], v[128:131], v[92:95], v[32:35]
    v_mfma_f32_16x16x32_bf16 v[20:23], v[128:131], v[164:167], v[20:23]
    v_mfma_f32_16x16x32_bf16 v[20:23], v[124:127], v[92:95], v[20:23]
    s_barrier
    s_waitcnt lgkmcnt(0)
    v_mfma_f32_16x16x32_bf16 v[24:27], v[124:127], v[96:99], v[24:27]
    ds_read_b64_tr_b16 v[88:89], v2 offset:30720
    v_mfma_f32_16x16x32_bf16 v[24:27], v[128:131], v[168:171], v[24:27]
    v_mfma_f32_16x16x32_bf16 v[36:39], v[128:131], v[96:99], v[36:39]
    ds_read_b64_tr_b16 v[90:91], v2 offset:32256
    v_mfma_f32_16x16x32_bf16 v[36:39], v[132:135], v[168:171], v[36:39]
    v_mfma_f32_16x16x32_bf16 v[48:51], v[132:135], v[96:99], v[48:51]
    ds_read_b128 v[100:103], v152 offset:40192
    v_mfma_f32_16x16x32_bf16 v[48:51], v[136:139], v[168:171], v[48:51]
    v_mfma_f32_16x16x32_bf16 v[60:63], v[136:139], v[96:99], v[60:63]
    ds_read_b64_tr_b16 v[160:161], v2 offset:36864
    v_mfma_f32_16x16x32_bf16 v[60:63], v[140:143], v[168:171], v[60:63]
    ds_read_b64_tr_b16 v[162:163], v2 offset:38400
    v_mfma_f32_16x16x32_bf16 v[72:75], v[140:143], v[96:99], v[72:75]
    ds_read_b128 v[104:107], v156 offset:26880
    v_mfma_f32_16x16x32_bf16 v[72:75], v[144:147], v[168:171], v[72:75]
    ds_read_b128 v[108:111], v153 offset:40320
    v_mfma_f32_16x16x32_bf16 v[84:87], v[144:147], v[96:99], v[84:87]
    ds_read_b128 v[112:115], v157 offset:27008
    v_mfma_f32_16x16x32_bf16 v[84:87], v[148:151], v[168:171], v[84:87]
    s_waitcnt lgkmcnt(2)
    v_mfma_f32_16x16x32_bf16 v[16:19], v[100:103], v[88:91], v[16:19]
    ds_read_b128 v[116:119], v154 offset:40448
    v_mfma_f32_16x16x32_bf16 v[16:19], v[104:107], v[160:163], v[16:19]
    s_waitcnt lgkmcnt(2)
    v_mfma_f32_16x16x32_bf16 v[28:31], v[104:107], v[88:91], v[28:31]
    ds_read_b128 v[120:123], v158 offset:27136
    v_mfma_f32_16x16x32_bf16 v[28:31], v[108:111], v[160:163], v[28:31]
    s_waitcnt lgkmcnt(2)
    v_mfma_f32_16x16x32_bf16 v[40:43], v[108:111], v[88:91], v[40:43]
    ds_read_b128 v[124:127], v155 offset:40576
    v_mfma_f32_16x16x32_bf16 v[40:43], v[112:115], v[160:163], v[40:43]
    s_barrier
    ds_read_b64_tr_b16 v[164:165], v2 offset:36896
    s_waitcnt lgkmcnt(3)
    v_mfma_f32_16x16x32_bf16 v[52:55], v[112:115], v[88:91], v[52:55]
    ds_read_b64_tr_b16 v[166:167], v2 offset:38432
    v_mfma_f32_16x16x32_bf16 v[52:55], v[116:119], v[160:163], v[52:55]
    ds_read_b64_tr_b16 v[92:93], v2 offset:30752
    s_waitcnt lgkmcnt(4)
    v_mfma_f32_16x16x32_bf16 v[64:67], v[116:119], v[88:91], v[64:67]
    ds_read_b64_tr_b16 v[94:95], v2 offset:32288
    v_mfma_f32_16x16x32_bf16 v[64:67], v[120:123], v[160:163], v[64:67]
    s_waitcnt lgkmcnt(4)
    v_mfma_f32_16x16x32_bf16 v[76:79], v[120:123], v[88:91], v[76:79]
    v_mfma_f32_16x16x32_bf16 v[76:79], v[124:127], v[160:163], v[76:79]
    s_waitcnt lgkmcnt(0)
    v_mfma_f32_16x16x32_bf16 v[80:83], v[124:127], v[164:167], v[80:83]
    ds_read_b64_tr_b16 v[96:97], v2 offset:30784
    v_mfma_f32_16x16x32_bf16 v[80:83], v[120:123], v[92:95], v[80:83]
    v_mfma_f32_16x16x32_bf16 v[68:71], v[120:123], v[164:167], v[68:71]
    ds_read_b64_tr_b16 v[98:99], v2 offset:32320
    v_mfma_f32_16x16x32_bf16 v[68:71], v[116:119], v[92:95], v[68:71]
    v_mfma_f32_16x16x32_bf16 v[56:59], v[116:119], v[164:167], v[56:59]
    ds_read_b64_tr_b16 v[168:169], v2 offset:36928
    v_mfma_f32_16x16x32_bf16 v[56:59], v[112:115], v[92:95], v[56:59]
    v_mfma_f32_16x16x32_bf16 v[44:47], v[112:115], v[164:167], v[44:47]
    ds_read_b64_tr_b16 v[170:171], v2 offset:38464
    v_mfma_f32_16x16x32_bf16 v[44:47], v[108:111], v[92:95], v[44:47]
    v_mfma_f32_16x16x32_bf16 v[32:35], v[108:111], v[164:167], v[32:35]
    v_mfma_f32_16x16x32_bf16 v[32:35], v[104:107], v[92:95], v[32:35]
    v_mfma_f32_16x16x32_bf16 v[20:23], v[104:107], v[164:167], v[20:23]
    v_mfma_f32_16x16x32_bf16 v[20:23], v[100:103], v[92:95], v[20:23]
    s_barrier
    s_waitcnt lgkmcnt(0)
    v_mfma_f32_16x16x32_bf16 v[24:27], v[100:103], v[96:99], v[24:27]
    ds_read_b64_tr_b16 v[88:89], v2 offset:43008
    v_mfma_f32_16x16x32_bf16 v[24:27], v[104:107], v[168:171], v[24:27]
    v_mfma_f32_16x16x32_bf16 v[36:39], v[104:107], v[96:99], v[36:39]
    ds_read_b64_tr_b16 v[90:91], v2 offset:44544
    v_mfma_f32_16x16x32_bf16 v[36:39], v[108:111], v[168:171], v[36:39]
    v_mfma_f32_16x16x32_bf16 v[48:51], v[108:111], v[96:99], v[48:51]
    ds_read_b64_tr_b16 v[160:161], v2 offset:49152
    v_mfma_f32_16x16x32_bf16 v[48:51], v[112:115], v[168:171], v[48:51]
    v_mfma_f32_16x16x32_bf16 v[60:63], v[112:115], v[96:99], v[60:63]
    ds_read_b64_tr_b16 v[162:163], v2 offset:50688
    v_mfma_f32_16x16x32_bf16 v[60:63], v[116:119], v[168:171], v[60:63]
    v_mfma_f32_16x16x32_bf16 v[72:75], v[116:119], v[96:99], v[72:75]
    ds_read_b128 v[128:131], v159 offset:27264
    v_mfma_f32_16x16x32_bf16 v[72:75], v[120:123], v[168:171], v[72:75]
    v_mfma_f32_16x16x32_bf16 v[84:87], v[120:123], v[96:99], v[84:87]
    ds_read_b128 v[132:135], v156 offset:40704
    v_mfma_f32_16x16x32_bf16 v[84:87], v[124:127], v[168:171], v[84:87]
    s_waitcnt lgkmcnt(2)
    v_mfma_f32_16x16x32_bf16 v[16:19], v[108:111], v[88:91], v[16:19]
L_pad_m1:
    s_cbranch_scc1 L_ret
    ds_read_b64_tr_b16 v[164:165], v2 offset:49184
    v_mfma_f32_16x16x32_bf16 v[16:19], v[112:115], v[160:163], v[16:19]
    v_mfma_f32_16x16x32_bf16 v[28:31], v[112:115], v[88:91], v[28:31]
    ds_read_b64_tr_b16 v[166:167], v2 offset:50720
    v_mfma_f32_16x16x32_bf16 v[28:31], v[116:119], v[160:163], v[28:31]
    v_mfma_f32_16x16x32_bf16 v[40:43], v[116:119], v[88:91], v[40:43]
    ds_read_b64_tr_b16 v[92:93], v2 offset:43040
    v_mfma_f32_16x16x32_bf16 v[40:43], v[120:123], v[160:163], v[40:43]
    s_barrier
    v_mfma_f32_16x16x32_bf16 v[52:55], v[120:123], v[88:91], v[52:55]
    ds_read_b64_tr_b16 v[94:95], v2 offset:44576
    v_mfma_f32_16x16x32_bf16 v[52:55], v[124:127], v[160:163], v[52:55]
    s_waitcnt lgkmcnt(5)
    v_mfma_f32_16x16x32_bf16 v[64:67], v[124:127], v[88:91], v[64:67]
    v_mfma_f32_16x16x32_bf16 v[64:67], v[128:131], v[160:163], v[64:67]
    s_waitcnt lgkmcnt(4)
    v_mfma_f32_16x16x32_bf16 v[76:79], v[128:131], v[88:91], v[76:79]
    v_mfma_f32_16x16x32_bf16 v[76:79], v[132:135], v[160:163], v[76:79]
    s_waitcnt lgkmcnt(0)
    v_mfma_f32_16x16x32_bf16 v[80:83], v[132:135], v[164:167], v[80:83]
    ds_read_b64_tr_b16 v[96:97], v2 offset:43072
    v_mfma_f32_16x16x32_bf16 v[80:83], v[128:131], v[92:95], v[80:83]
    v_mfma_f32_16x16x32_bf16 v[68:71], v[128:131], v[164:167], v[68:71]
    ds_read_b64_tr_b16 v[98:99], v2 offset:44608
    v_mfma_f32_16x16x32_bf16 v[68:71], v[124:127], v[92:95], v[68:71]
    v_mfma_f32_16x16x32_bf16 v[56:59], v[124:127], v[164:167], v[56:59]
    ds_read_b64_tr_b16 v[168:169], v2 offset:49216
    v_mfma_f32_16x16x32_bf16 v[56:59], v[120:123], v[92:95], v[56:59]
    v_mfma_f32_16x16x32_bf16 v[44:47], v[120:123], v[164:167], v[44:47]
    ds_read_b64_tr_b16 v[170:171], v2 offset:50752
    v_mfma_f32_16x16x32_bf16 v[44:47], v[116:119], v[92:95], v[44:47]
    v_mfma_f32_16x16x32_bf16 v[32:35], v[116:119], v[164:167], v[32:35]
    v_mfma_f32_16x16x32_bf16 v[32:35], v[112:115], v[92:95], v[32:35]
    v_mfma_f32_16x16x32_bf16 v[20:23], v[112:115], v[164:167], v[20:23]
    v_mfma_f32_16x16x32_bf16 v[20:23], v[108:111], v[92:95], v[20:23]
    s_barrier
    s_waitcnt lgkmcnt(0)
    v_mfma_f32_16x16x32_bf16 v[24:27], v[108:111], v[96:99], v[24:27]
    ds_read_b64_tr_b16 v[88:89], v2 offset:55296
    v_mfma_f32_16x16x32_bf16 v[24:27], v[112:115], v[168:171], v[24:27]
    v_mfma_f32_16x16x32_bf16 v[36:39], v[112:115], v[96:99], v[36:39]
    ds_read_b64_tr_b16 v[90:91], v2 offset:56832
    v_mfma_f32_16x16x32_bf16 v[36:39], v[116:119], v[168:171], v[36:39]
    v_mfma_f32_16x16x32_bf16 v[48:51], v[116:119], v[96:99], v[48:51]
    ds_read_b64_tr_b16 v[160:161], v2 offset:61440
    v_mfma_f32_16x16x32_bf16 v[48:51], v[120:123], v[168:171], v[48:51]
    v_mfma_f32_16x16x32_bf16 v[60:63], v[120:123], v[96:99], v[60:63]
    ds_read_b64_tr_b16 v[162:163], v2 offset:62976
    v_mfma_f32_16x16x32_bf16 v[60:63], v[124:127], v[168:171], v[60:63]
    v_mfma_f32_16x16x32_bf16 v[72:75], v[124:127], v[96:99], v[72:75]
    ds_read_b128 v[136:139], v152 offset:27392
    v_mfma_f32_16x16x32_bf16 v[72:75], v[128:131], v[168:171], v[72:75]
    v_mfma_f32_16x16x32_bf16 v[84:87], v[128:131], v[96:99], v[84:87]
    ds_read_b128 v[140:143], v157 offset:40832
    v_mfma_f32_16x16x32_bf16 v[84:87], v[132:135], v[168:171], v[84:87]
    s_waitcnt lgkmcnt(2)
    v_mfma_f32_16x16x32_bf16 v[16:19], v[116:119], v[88:91], v[16:19]
    ds_read_b64_tr_b16 v[164:165], v2 offset:61472
    v_mfma_f32_16x16x32_bf16 v[16:19], v[120:123], v[160:163], v[16:19]
    v_mfma_f32_16x16x32_bf16 v[28:31], v[120:123], v[88:91], v[28:31]
    ds_read_b64_tr_b16 v[166:167], v2 offset:63008
    v_mfma_f32_16x16x32_bf16 v[28:31], v[124:127], v[160:163], v[28:31]
    v_mfma_f32_16x16x32_bf16 v[40:43], v[124:127], v[88:91], v[40:43]
    ds_read_b64_tr_b16 v[92:93], v2 offset:55328
    v_mfma_f32_16x16x32_bf16 v[40:43], v[128:131], v[160:163], v[40:43]
    s_barrier
    v_mfma_f32_16x16x32_bf16 v[52:55], v[128:131], v[88:91], v[52:55]
    ds_read_b64_tr_b16 v[94:95], v2 offset:56864
    v_mfma_f32_16x16x32_bf16 v[52:55], v[132:135], v[160:163], v[52:55]
    s_waitcnt lgkmcnt(5)
    v_mfma_f32_16x16x32_bf16 v[64:67], v[132:135], v[88:91], v[64:67]
    v_mfma_f32_16x16x32_bf16 v[64:67], v[136:139], v[160:163], v[64:67]
    s_waitcnt lgkmcnt(4)
    v_mfma_f32_16x16x32_bf16 v[76:79], v[136:139], v[88:91], v[76:79]
    v_mfma_f32_16x16x32_bf16 v[76:79], v[140:143], v[160:163], v[76:79]
    s_waitcnt lgkmcnt(0)
    v_mfma_f32_16x16x32_bf16 v[80:83], v[140:143], v[164:167], v[80:83]
    ds_read_b64_tr_b16 v[96:97], v2 offset:55360
    v_mfma_f32_16x16x32_bf16 v[80:83], v[136:139], v[92:95], v[80:83]
    v_mfma_f32_16x16x32_bf16 v[68:71], v[136:139], v[164:167], v[68:71]
    ds_read_b64_tr_b16 v[98:99], v2 offset:56896
    v_mfma_f32_16x16x32_bf16 v[68:71], v[132:135], v[92:95], v[68:71]
    v_mfma_f32_16x16x32_bf16 v[56:59], v[132:135], v[164:167], v[56:59]
    ds_read_b64_tr_b16 v[168:169], v2 offset:61504
    v_mfma_f32_16x16x32_bf16 v[56:59], v[128:131], v[92:95], v[56:59]
    v_mfma_f32_16x16x32_bf16 v[44:47], v[128:131], v[164:167], v[44:47]
    ds_read_b64_tr_b16 v[170:171], v2 offset:63040
    v_mfma_f32_16x16x32_bf16 v[44:47], v[124:127], v[92:95], v[44:47]
    v_mfma_f32_16x16x32_bf16 v[32:35], v[124:127], v[164:167], v[32:35]
    v_mfma_f32_16x16x32_bf16 v[32:35], v[120:123], v[92:95], v[32:35]
    v_mfma_f32_16x16x32_bf16 v[20:23], v[120:123], v[164:167], v[20:23]
    v_mfma_f32_16x16x32_bf16 v[20:23], v[116:119], v[92:95], v[20:23]
    s_barrier
    s_waitcnt lgkmcnt(0)
    v_mfma_f32_16x16x32_bf16 v[24:27], v[116:119], v[96:99], v[24:27]
    ds_read_b64_tr_b16 v[88:89], v2 offset:0
    v_mfma_f32_16x16x32_bf16 v[24:27], v[120:123], v[168:171], v[24:27]
    v_mfma_f32_16x16x32_bf16 v[36:39], v[120:123], v[96:99], v[36:39]
    ds_read_b64_tr_b16 v[90:91], v2 offset:1536
    v_mfma_f32_16x16x32_bf16 v[36:39], v[124:127], v[168:171], v[36:39]
    v_mfma_f32_16x16x32_bf16 v[48:51], v[124:127], v[96:99], v[48:51]
    ds_read_b64_tr_b16 v[160:161], v2 offset:6144
    v_mfma_f32_16x16x32_bf16 v[48:51], v[128:131], v[168:171], v[48:51]
    v_mfma_f32_16x16x32_bf16 v[60:63], v[128:131], v[96:99], v[60:63]
    ds_read_b64_tr_b16 v[162:163], v2 offset:7680
    v_mfma_f32_16x16x32_bf16 v[60:63], v[132:135], v[168:171], v[60:63]
    v_mfma_f32_16x16x32_bf16 v[72:75], v[132:135], v[96:99], v[72:75]
    ds_read_b128 v[144:147], v153 offset:27520
    v_mfma_f32_16x16x32_bf16 v[72:75], v[136:139], v[168:171], v[72:75]
    v_mfma_f32_16x16x32_bf16 v[84:87], v[136:139], v[96:99], v[84:87]
    ds_read_b128 v[148:151], v158 offset:40960
    v_mfma_f32_16x16x32_bf16 v[84:87], v[140:143], v[168:171], v[84:87]
    s_waitcnt lgkmcnt(2)
    v_mfma_f32_16x16x32_bf16 v[16:19], v[124:127], v[88:91], v[16:19]
    ds_read_b64_tr_b16 v[164:165], v2 offset:6176
    v_mfma_f32_16x16x32_bf16 v[16:19], v[128:131], v[160:163], v[16:19]
    v_mfma_f32_16x16x32_bf16 v[28:31], v[128:131], v[88:91], v[28:31]
    ds_read_b64_tr_b16 v[166:167], v2 offset:7712
    v_mfma_f32_16x16x32_bf16 v[28:31], v[132:135], v[160:163], v[28:31]
    v_mfma_f32_16x16x32_bf16 v[40:43], v[132:135], v[88:91], v[40:43]
    ds_read_b64_tr_b16 v[92:93], v2 offset:32
    v_mfma_f32_16x16x32_bf16 v[40:43], v[136:139], v[160:163], v[40:43]
    s_barrier
    v_mfma_f32_16x16x32_bf16 v[52:55], v[136:139], v[88:91], v[52:55]
    ds_read_b64_tr_b16 v[94:95], v2 offset:1568
    v_mfma_f32_16x16x32_bf16 v[52:55], v[140:143], v[160:163], v[52:55]
    s_waitcnt lgkmcnt(5)
    v_mfma_f32_16x16x32_bf16 v[64:67], v[140:143], v[88:91], v[64:67]
    v_mfma_f32_16x16x32_bf16 v[64:67], v[144:147], v[160:163], v[64:67]
    s_waitcnt lgkmcnt(4)
    v_mfma_f32_16x16x32_bf16 v[76:79], v[144:147], v[88:91], v[76:79]
    v_mfma_f32_16x16x32_bf16 v[76:79], v[148:151], v[160:163], v[76:79]
    s_waitcnt lgkmcnt(0)
    v_mfma_f32_16x16x32_bf16 v[80:83], v[148:151], v[164:167], v[80:83]
    ds_read_b64_tr_b16 v[96:97], v2 offset:64
    v_mfma_f32_16x16x32_bf16 v[80:83], v[144:147], v[92:95], v[80:83]
    v_mfma_f32_16x16x32_bf16 v[68:71], v[144:147], v[164:167], v[68:71]
    ds_read_b64_tr_b16 v[98:99], v2 offset:1600
    v_mfma_f32_16x16x32_bf16 v[68:71], v[140:143], v[92:95], v[68:71]
    v_mfma_f32_16x16x32_bf16 v[56:59], v[140:143], v[164:167], v[56:59]
    ds_read_b64_tr_b16 v[168:169], v2 offset:6208
    v_mfma_f32_16x16x32_bf16 v[56:59], v[136:139], v[92:95], v[56:59]
    v_mfma_f32_16x16x32_bf16 v[44:47], v[136:139], v[164:167], v[44:47]
    ds_read_b64_tr_b16 v[170:171], v2 offset:7744
    v_mfma_f32_16x16x32_bf16 v[44:47], v[132:135], v[92:95], v[44:47]
    v_mfma_f32_16x16x32_bf16 v[32:35], v[132:135], v[164:167], v[32:35]
    v_mfma_f32_16x16x32_bf16 v[32:35], v[128:131], v[92:95], v[32:35]
    v_mfma_f32_16x16x32_bf16 v[20:23], v[128:131], v[164:167], v[20:23]
    v_mfma_f32_16x16x32_bf16 v[20:23], v[124:127], v[92:95], v[20:23]
    s_barrier
    s_waitcnt lgkmcnt(0)
    v_mfma_f32_16x16x32_bf16 v[24:27], v[124:127], v[96:99], v[24:27]
    ds_read_b128 v[88:91], v1 offset:12288
    v_mfma_f32_16x16x32_bf16 v[24:27], v[128:131], v[168:171], v[24:27]
    v_mfma_f32_16x16x32_bf16 v[36:39], v[128:131], v[96:99], v[36:39]
    ds_read_b128 v[100:103], v156 offset:40192
    v_mfma_f32_16x16x32_bf16 v[36:39], v[132:135], v[168:171], v[36:39]
    v_mfma_f32_16x16x32_bf16 v[48:51], v[132:135], v[96:99], v[48:51]
    ds_read_b128 v[160:163], v1 offset:18432
    v_mfma_f32_16x16x32_bf16 v[48:51], v[136:139], v[168:171], v[48:51]
    v_mfma_f32_16x16x32_bf16 v[60:63], v[136:139], v[96:99], v[60:63]
    ds_read_b128 v[104:107], v152 offset:256
    v_mfma_f32_16x16x32_bf16 v[60:63], v[140:143], v[168:171], v[60:63]
    v_mfma_f32_16x16x32_bf16 v[72:75], v[140:143], v[96:99], v[72:75]
    ds_read_b128 v[108:111], v157 offset:40320
    v_mfma_f32_16x16x32_bf16 v[72:75], v[144:147], v[168:171], v[72:75]
    v_mfma_f32_16x16x32_bf16 v[84:87], v[144:147], v[96:99], v[84:87]
    ds_read_b128 v[112:115], v153 offset:384
    v_mfma_f32_16x16x32_bf16 v[84:87], v[148:151], v[168:171], v[84:87]
    s_waitcnt lgkmcnt(2)
    v_mfma_f32_16x16x32_bf16 v[16:19], v[100:103], v[88:91], v[16:19]
    ds_read_b128 v[116:119], v158 offset:40448
    v_mfma_f32_16x16x32_bf16 v[16:19], v[104:107], v[160:163], v[16:19]
    s_waitcnt lgkmcnt(2)
    v_mfma_f32_16x16x32_bf16 v[28:31], v[104:107], v[88:91], v[28:31]
    ds_read_b128 v[120:123], v154 offset:512
    v_mfma_f32_16x16x32_bf16 v[28:31], v[108:111], v[160:163], v[28:31]
    s_waitcnt lgkmcnt(2)
    v_mfma_f32_16x16x32_bf16 v[40:43], v[108:111], v[88:91], v[40:43]
    ds_read_b128 v[124:127], v159 offset:40576
    v_mfma_f32_16x16x32_bf16 v[40:43], v[112:115], v[160:163], v[40:43]
    s_barrier
    ds_read_b128 v[164:167], v1 offset:19456
    s_waitcnt lgkmcnt(3)
    v_mfma_f32_16x16x32_bf16 v[52:55], v[112:115], v[88:91], v[52:55]
    ds_read_b128 v[92:95], v1 offset:13312
    v_mfma_f32_16x16x32_bf16 v[52:55], v[116:119], v[160:163], v[52:55]
    s_waitcnt lgkmcnt(3)
    v_mfma_f32_16x16x32_bf16 v[64:67], v[116:119], v[88:91], v[64:67]
    v_mfma_f32_16x16x32_bf16 v[64:67], v[120:123], v[160:163], v[64:67]
    s_waitcnt lgkmcnt(2)
    v_mfma_f32_16x16x32_bf16 v[76:79], v[120:123], v[88:91], v[76:79]
    v_mfma_f32_16x16x32_bf16 v[76:79], v[124:127], v[160:163], v[76:79]
    s_waitcnt lgkmcnt(0)
    v_mfma_f32_16x16x32_bf16 v[80:83], v[124:127], v[164:167], v[80:83]
    ds_read_b128 v[96:99], v1 offset:14336
    v_mfma_f32_16x16x32_bf16 v[80:83], v[120:123], v[92:95], v[80:83]
    v_mfma_f32_16x16x32_bf16 v[68:71], v[120:123], v[164:167], v[68:71]
    ds_read_b128 v[168:171], v1 offset:20480
    v_mfma_f32_16x16x32_bf16 v[68:71], v[116:119], v[92:95], v[68:71]
    v_mfma_f32_16x16x32_bf16 v[56:59], v[116:119], v[164:167], v[56:59]
    v_mfma_f32_16x16x32_bf16 v[56:59], v[112:115], v[92:95], v[56:59]
    v_mfma_f32_16x16x32_bf16 v[44:47], v[112:115], v[164:167], v[44:47]
    v_mfma_f32_16x16x32_bf16 v[44:47], v[108:111], v[92:95], v[44:47]
    v_mfma_f32_16x16x32_bf16 v[32:35], v[108:111], v[164:167], v[32:35]
    v_mfma_f32_16x16x32_bf16 v[32:35], v[104:107], v[92:95], v[32:35]
    v_mfma_f32_16x16x32_bf16 v[20:23], v[104:107], v[164:167], v[20:23]
    v_mfma_f32_16x16x32_bf16 v[20:23], v[100:103], v[92:95], v[20:23]
    s_barrier
    s_waitcnt lgkmcnt(0)
    v_mfma_f32_16x16x32_bf16 v[24:27], v[100:103], v[96:99], v[24:27]
    ds_read_b128 v[88:91], v1 offset:24576
    v_mfma_f32_16x16x32_bf16 v[24:27], v[104:107], v[168:171], v[24:27]
    v_mfma_f32_16x16x32_bf16 v[36:39], v[104:107], v[96:99], v[36:39]
    ds_read_b128 v[160:163], v1 offset:30720
    v_mfma_f32_16x16x32_bf16 v[36:39], v[108:111], v[168:171], v[36:39]
    v_mfma_f32_16x16x32_bf16 v[48:51], v[108:111], v[96:99], v[48:51]
    v_mfma_f32_16x16x32_bf16 v[48:51], v[112:115], v[168:171], v[48:51]
    v_mfma_f32_16x16x32_bf16 v[60:63], v[112:115], v[96:99], v[60:63]
    v_mfma_f32_16x16x32_bf16 v[60:63], v[116:119], v[168:171], v[60:63]
    v_mfma_f32_16x16x32_bf16 v[72:75], v[116:119], v[96:99], v[72:75]
    ds_read_b128 v[128:131], v155 offset:640
    v_mfma_f32_16x16x32_bf16 v[72:75], v[120:123], v[168:171], v[72:75]
    v_mfma_f32_16x16x32_bf16 v[84:87], v[120:123], v[96:99], v[84:87]
    ds_read_b128 v[132:135], v152 offset:40704
    v_mfma_f32_16x16x32_bf16 v[84:87], v[124:127], v[168:171], v[84:87]
    s_waitcnt lgkmcnt(2)
    v_mfma_f32_16x16x32_bf16 v[16:19], v[108:111], v[88:91], v[16:19]
    ds_read_b128 v[164:167], v1 offset:31744
    v_mfma_f32_16x16x32_bf16 v[16:19], v[112:115], v[160:163], v[16:19]
    v_mfma_f32_16x16x32_bf16 v[28:31], v[112:115], v[88:91], v[28:31]
    ds_read_b128 v[92:95], v1 offset:25600
    v_mfma_f32_16x16x32_bf16 v[28:31], v[116:119], v[160:163], v[28:31]
    v_mfma_f32_16x16x32_bf16 v[40:43], v[116:119], v[88:91], v[40:43]
    v_mfma_f32_16x16x32_bf16 v[40:43], v[120:123], v[160:163], v[40:43]
    s_barrier
    v_mfma_f32_16x16x32_bf16 v[52:55], v[120:123], v[88:91], v[52:55]
    v_mfma_f32_16x16x32_bf16 v[52:55], v[124:127], v[160:163], v[52:55]
    s_waitcnt lgkmcnt(3)
    v_mfma_f32_16x16x32_bf16 v[64:67], v[124:127], v[88:91], v[64:67]
    v_mfma_f32_16x16x32_bf16 v[64:67], v[128:131], v[160:163], v[64:67]
    s_waitcnt lgkmcnt(2)
    v_mfma_f32_16x16x32_bf16 v[76:79], v[128:131], v[88:91], v[76:79]
    v_mfma_f32_16x16x32_bf16 v[76:79], v[132:135], v[160:163], v[76:79]
    s_waitcnt lgkmcnt(0)
    v_mfma_f32_16x16x32_bf16 v[80:83], v[132:135], v[164:167], v[80:83]
    ds_read_b128 v[96:99], v1 offset:26624
    v_mfma_f32_16x16x32_bf16 v[80:83], v[128:131], v[92:95], v[80:83]
    v_mfma_f32_16x16x32_bf16 v[68:71], v[128:131], v[164:167], v[68:71]
    ds_read_b128 v[168:171], v1 offset:32768
    v_mfma_f32_16x16x32_bf16 v[68:71], v[124:127], v[92:95], v[68:71]
    v_mfma_f32_16x16x32_bf16 v[56:59], v[124:127], v[164:167], v[56:59]
    v_mfma_f32_16x16x32_bf16 v[56:59], v[120:123], v[92:95], v[56:59]
    v_mfma_f32_16x16x32_bf16 v[44:47], v[120:123], v[164:167], v[44:47]
    v_mfma_f32_16x16x32_bf16 v[44:47], v[116:119], v[92:95], v[44:47]
    v_mfma_f32_16x16x32_bf16 v[32:35], v[116:119], v[164:167], v[32:35]
    v_mfma_f32_16x16x32_bf16 v[32:35], v[112:115], v[92:95], v[32:35]
    v_mfma_f32_16x16x32_bf16 v[20:23], v[112:115], v[164:167], v[20:23]
    v_mfma_f32_16x16x32_bf16 v[20:23], v[108:111], v[92:95], v[20:23]
    s_barrier
    s_waitcnt lgkmcnt(0)
    v_mfma_f32_16x16x32_bf16 v[24:27], v[108:111], v[96:99], v[24:27]
    ds_read_b128 v[88:91], v1 offset:36864
    v_mfma_f32_16x16x32_bf16 v[24:27], v[112:115], v[168:171], v[24:27]
    v_mfma_f32_16x16x32_bf16 v[36:39], v[112:115], v[96:99], v[36:39]
    ds_read_b128 v[160:163], v1 offset:43008
    v_mfma_f32_16x16x32_bf16 v[36:39], v[116:119], v[168:171], v[36:39]
    v_mfma_f32_16x16x32_bf16 v[48:51], v[116:119], v[96:99], v[48:51]
    v_mfma_f32_16x16x32_bf16 v[48:51], v[120:123], v[168:171], v[48:51]
    v_mfma_f32_16x16x32_bf16 v[60:63], v[120:123], v[96:99], v[60:63]
    v_mfma_f32_16x16x32_bf16 v[60:63], v[124:127], v[168:171], v[60:63]
    v_mfma_f32_16x16x32_bf16 v[72:75], v[124:127], v[96:99], v[72:75]
    ds_read_b128 v[136:139], v156 offset:768
    v_mfma_f32_16x16x32_bf16 v[72:75], v[128:131], v[168:171], v[72:75]
    v_mfma_f32_16x16x32_bf16 v[84:87], v[128:131], v[96:99], v[84:87]
    ds_read_b128 v[140:143], v153 offset:40832
    v_mfma_f32_16x16x32_bf16 v[84:87], v[132:135], v[168:171], v[84:87]
    s_waitcnt lgkmcnt(2)
    v_mfma_f32_16x16x32_bf16 v[16:19], v[116:119], v[88:91], v[16:19]
    ds_read_b128 v[164:167], v1 offset:44032
    v_mfma_f32_16x16x32_bf16 v[16:19], v[120:123], v[160:163], v[16:19]
    v_mfma_f32_16x16x32_bf16 v[28:31], v[120:123], v[88:91], v[28:31]
    ds_read_b128 v[92:95], v1 offset:37888
    v_mfma_f32_16x16x32_bf16 v[28:31], v[124:127], v[160:163], v[28:31]
    v_mfma_f32_16x16x32_bf16 v[40:43], v[124:127], v[88:91], v[40:43]
    v_mfma_f32_16x16x32_bf16 v[40:43], v[128:131], v[160:163], v[40:43]
    s_barrier
    v_mfma_f32_16x16x32_bf16 v[52:55], v[128:131], v[88:91], v[52:55]
    v_mfma_f32_16x16x32_bf16 v[52:55], v[132:135], v[160:163], v[52:55]
    s_waitcnt lgkmcnt(3)
    v_mfma_f32_16x16x32_bf16 v[64:67], v[132:135], v[88:91], v[64:67]
    v_mfma_f32_16x16x32_bf16 v[64:67], v[136:139], v[160:163], v[64:67]
    s_waitcnt lgkmcnt(2)
    v_mfma_f32_16x16x32_bf16 v[76:79], v[136:139], v[88:91], v[76:79]
    v_mfma_f32_16x16x32_bf16 v[76:79], v[140:143], v[160:163], v[76:79]
    s_waitcnt lgkmcnt(0)
    v_mfma_f32_16x16x32_bf16 v[80:83], v[140:143], v[164:167], v[80:83]
    ds_read_b128 v[96:99], v1 offset:38912
    v_mfma_f32_16x16x32_bf16 v[80:83], v[136:139], v[92:95], v[80:83]
    v_mfma_f32_16x16x32_bf16 v[68:71], v[136:139], v[164:167], v[68:71]
    ds_read_b128 v[168:171], v1 offset:45056
    v_mfma_f32_16x16x32_bf16 v[68:71], v[132:135], v[92:95], v[68:71]
    v_mfma_f32_16x16x32_bf16 v[56:59], v[132:135], v[164:167], v[56:59]
    v_mfma_f32_16x16x32_bf16 v[56:59], v[128:131], v[92:95], v[56:59]
    v_mfma_f32_16x16x32_bf16 v[44:47], v[128:131], v[164:167], v[44:47]
    v_mfma_f32_16x16x32_bf16 v[44:47], v[124:127], v[92:95], v[44:47]
    v_mfma_f32_16x16x32_bf16 v[32:35], v[124:127], v[164:167], v[32:35]
    v_mfma_f32_16x16x32_bf16 v[32:35], v[120:123], v[92:95], v[32:35]
    v_mfma_f32_16x16x32_bf16 v[20:23], v[120:123], v[164:167], v[20:23]
    v_mfma_f32_16x16x32_bf16 v[20:23], v[116:119], v[92:95], v[20:23]
    s_barrier
    s_waitcnt lgkmcnt(0)
    v_mfma_f32_16x16x32_bf16 v[24:27], v[116:119], v[96:99], v[24:27]
    ds_read_b128 v[88:91], v1 offset:49152
    v_mfma_f32_16x16x32_bf16 v[24:27], v[120:123], v[168:171], v[24:27]
    v_mfma_f32_16x16x32_bf16 v[36:39], v[120:123], v[96:99], v[36:39]
    ds_read_b128 v[160:163], v1 offset:55296
    v_mfma_f32_16x16x32_bf16 v[36:39], v[124:127], v[168:171], v[36:39]
    v_mfma_f32_16x16x32_bf16 v[48:51], v[124:127], v[96:99], v[48:51]
    v_mfma_f32_16x16x32_bf16 v[48:51], v[128:131], v[168:171], v[48:51]
    v_mfma_f32_16x16x32_bf16 v[60:63], v[128:131], v[96:99], v[60:63]
    v_mfma_f32_16x16x32_bf16 v[60:63], v[132:135], v[168:171], v[60:63]
    v_mfma_f32_16x16x32_bf16 v[72:75], v[132:135], v[96:99], v[72:75]
    ds_read_b128 v[144:147], v157 offset:896
    v_mfma_f32_16x16x32_bf16 v[72:75], v[136:139], v[168:171], v[72:75]
    v_mfma_f32_16x16x32_bf16 v[84:87], v[136:139], v[96:99], v[84:87]
    ds_read_b128 v[148:151], v154 offset:40960
    v_mfma_f32_16x16x32_bf16 v[84:87], v[140:143], v[168:171], v[84:87]
    s_waitcnt lgkmcnt(2)
    v_mfma_f32_16x16x32_bf16 v[16:19], v[124:127], v[88:91], v[16:19]
    ds_read_b128 v[164:167], v1 offset:56320
    v_mfma_f32_16x16x32_bf16 v[16:19], v[128:131], v[160:163], v[16:19]
    v_mfma_f32_16x16x32_bf16 v[28:31], v[128:131], v[88:91], v[28:31]
    ds_read_b128 v[92:95], v1 offset:50176
    v_mfma_f32_16x16x32_bf16 v[28:31], v[132:135], v[160:163], v[28:31]
    v_mfma_f32_16x16x32_bf16 v[40:43], v[132:135], v[88:91], v[40:43]
    v_mfma_f32_16x16x32_bf16 v[40:43], v[136:139], v[160:163], v[40:43]
    s_barrier
    v_mfma_f32_16x16x32_bf16 v[52:55], v[136:139], v[88:91], v[52:55]
    v_mfma_f32_16x16x32_bf16 v[52:55], v[140:143], v[160:163], v[52:55]
    s_waitcnt lgkmcnt(3)
    v_mfma_f32_16x16x32_bf16 v[64:67], v[140:143], v[88:91], v[64:67]
    v_mfma_f32_16x16x32_bf16 v[64:67], v[144:147], v[160:163], v[64:67]
    s_waitcnt lgkmcnt(2)
    v_mfma_f32_16x16x32_bf16 v[76:79], v[144:147], v[88:91], v[76:79]
    v_mfma_f32_16x16x32_bf16 v[76:79], v[148:151], v[160:163], v[76:79]
    s_waitcnt lgkmcnt(0)
    v_mfma_f32_16x16x32_bf16 v[80:83], v[148:151], v[164:167], v[80:83]
    ds_read_b128 v[96:99], v1 offset:51200
    v_mfma_f32_16x16x32_bf16 v[80:83], v[144:147], v[92:95], v[80:83]
    v_mfma_f32_16x16x32_bf16 v[68:71], v[144:147], v[164:167], v[68:71]
    ds_read_b128 v[168:171], v1 offset:57344
    v_mfma_f32_16x16x32_bf16 v[68:71], v[140:143], v[92:95], v[68:71]
    v_mfma_f32_16x16x32_bf16 v[56:59], v[140:143], v[164:167], v[56:59]
    v_mfma_f32_16x16x32_bf16 v[56:59], v[136:139], v[92:95], v[56:59]
    v_mfma_f32_16x16x32_bf16 v[44:47], v[136:139], v[164:167], v[44:47]
    v_mfma_f32_16x16x32_bf16 v[44:47], v[132:135], v[92:95], v[44:47]
    v_mfma_f32_16x16x32_bf16 v[32:35], v[132:135], v[164:167], v[32:35]
    v_mfma_f32_16x16x32_bf16 v[32:35], v[128:131], v[92:95], v[32:35]
    v_mfma_f32_16x16x32_bf16 v[20:23], v[128:131], v[164:167], v[20:23]
    v_mfma_f32_16x16x32_bf16 v[20:23], v[124:127], v[92:95], v[20:23]
    s_barrier
    s_waitcnt lgkmcnt(0)
    v_mfma_f32_16x16x32_bf16 v[24:27], v[124:127], v[96:99], v[24:27]
    ds_read_b128 v[88:91], v1 offset:61440
    v_mfma_f32_16x16x32_bf16 v[24:27], v[128:131], v[168:171], v[24:27]
    v_mfma_f32_16x16x32_bf16 v[36:39], v[128:131], v[96:99], v[36:39]
    ds_read_b128 v[100:103], v152 offset:13568
    v_mfma_f32_16x16x32_bf16 v[36:39], v[132:135], v[168:171], v[36:39]
    v_mfma_f32_16x16x32_bf16 v[48:51], v[132:135], v[96:99], v[48:51]
    ds_read_b128 v[160:163], v1 offset:0
    v_mfma_f32_16x16x32_bf16 v[48:51], v[136:139], v[168:171], v[48:51]
    v_mfma_f32_16x16x32_bf16 v[60:63], v[136:139], v[96:99], v[60:63]
    ds_read_b128 v[104:107], v156 offset:256
    v_mfma_f32_16x16x32_bf16 v[60:63], v[140:143], v[168:171], v[60:63]
    v_mfma_f32_16x16x32_bf16 v[72:75], v[140:143], v[96:99], v[72:75]
    ds_read_b128 v[108:111], v153 offset:13696
    v_mfma_f32_16x16x32_bf16 v[72:75], v[144:147], v[168:171], v[72:75]
    v_mfma_f32_16x16x32_bf16 v[84:87], v[144:147], v[96:99], v[84:87]
    ds_read_b128 v[112:115], v157 offset:384
    v_mfma_f32_16x16x32_bf16 v[84:87], v[148:151], v[168:171], v[84:87]
    s_waitcnt lgkmcnt(2)
    v_mfma_f32_16x16x32_bf16 v[16:19], v[100:103], v[88:91], v[16:19]
    ds_read_b128 v[116:119], v154 offset:13824
    v_mfma_f32_16x16x32_bf16 v[16:19], v[104:107], v[160:163], v[16:19]
    s_waitcnt lgkmcnt(2)
    v_mfma_f32_16x16x32_bf16 v[28:31], v[104:107], v[88:91], v[28:31]
    ds_read_b128 v[120:123], v158 offset:512
    v_mfma_f32_16x16x32_bf16 v[28:31], v[108:111], v[160:163], v[28:31]
    s_waitcnt lgkmcnt(2)
    v_mfma_f32_16x16x32_bf16 v[40:43], v[108:111], v[88:91], v[40:43]
    ds_read_b128 v[124:127], v155 offset:13952
    v_mfma_f32_16x16x32_bf16 v[40:43], v[112:115], v[160:163], v[40:43]
    s_barrier
    ds_read_b128 v[164:167], v1 offset:1024
    s_waitcnt lgkmcnt(3)
    v_mfma_f32_16x16x32_bf16 v[52:55], v[112:115], v[88:91], v[52:55]
    ds_read_b128 v[92:95], v1 offset:62464
    v_mfma_f32_16x16x32_bf16 v[52:55], v[116:119], v[160:163], v[52:55]
    s_waitcnt lgkmcnt(3)
    v_mfma_f32_16x16x32_bf16 v[64:67], v[116:119], v[88:91], v[64:67]
    v_mfma_f32_16x16x32_bf16 v[64:67], v[120:123], v[160:163], v[64:67]
    s_waitcnt lgkmcnt(2)
    v_mfma_f32_16x16x32_bf16 v[76:79], v[120:123], v[88:91], v[76:79]
    v_mfma_f32_16x16x32_bf16 v[76:79], v[124:127], v[160:163], v[76:79]
    s_waitcnt lgkmcnt(0)
    v_mfma_f32_16x16x32_bf16 v[80:83], v[124:127], v[164:167], v[80:83]
    ds_read_b128 v[96:99], v1 offset:63488
    v_mfma_f32_16x16x32_bf16 v[80:83], v[120:123], v[92:95], v[80:83]
    v_mfma_f32_16x16x32_bf16 v[68:71], v[120:123], v[164:167], v[68:71]
    ds_read_b128 v[168:171], v1 offset:2048
    v_mfma_f32_16x16x32_bf16 v[68:71], v[116:119], v[92:95], v[68:71]
    v_mfma_f32_16x16x32_bf16 v[56:59], v[116:119], v[164:167], v[56:59]
    v_mfma_f32_16x16x32_bf16 v[56:59], v[112:115], v[92:95], v[56:59]
    v_mfma_f32_16x16x32_bf16 v[44:47], v[112:115], v[164:167], v[44:47]
    v_mfma_f32_16x16x32_bf16 v[44:47], v[108:111], v[92:95], v[44:47]
    v_mfma_f32_16x16x32_bf16 v[32:35], v[108:111], v[164:167], v[32:35]
    v_mfma_f32_16x16x32_bf16 v[32:35], v[104:107], v[92:95], v[32:35]
    v_mfma_f32_16x16x32_bf16 v[20:23], v[104:107], v[164:167], v[20:23]
    v_mfma_f32_16x16x32_bf16 v[20:23], v[100:103], v[92:95], v[20:23]
    s_barrier
    s_waitcnt lgkmcnt(0)
    v_mfma_f32_16x16x32_bf16 v[24:27], v[100:103], v[96:99], v[24:27]
    ds_read_b128 v[88:91], v1 offset:6144
    v_mfma_f32_16x16x32_bf16 v[24:27], v[104:107], v[168:171], v[24:27]
    v_mfma_f32_16x16x32_bf16 v[36:39], v[104:107], v[96:99], v[36:39]
    ds_read_b128 v[160:163], v1 offset:12288
    v_mfma_f32_16x16x32_bf16 v[36:39], v[108:111], v[168:171], v[36:39]
    v_mfma_f32_16x16x32_bf16 v[48:51], v[108:111], v[96:99], v[48:51]
    v_mfma_f32_16x16x32_bf16 v[48:51], v[112:115], v[168:171], v[48:51]
    v_mfma_f32_16x16x32_bf16 v[60:63], v[112:115], v[96:99], v[60:63]
    v_mfma_f32_16x16x32_bf16 v[60:63], v[116:119], v[168:171], v[60:63]
    v_mfma_f32_16x16x32_bf16 v[72:75], v[116:119], v[96:99], v[72:75]
    ds_read_b128 v[128:131], v159 offset:640
    v_mfma_f32_16x16x32_bf16 v[72:75], v[120:123], v[168:171], v[72:75]
    v_mfma_f32_16x16x32_bf16 v[84:87], v[120:123], v[96:99], v[84:87]
    ds_read_b128 v[132:135], v156 offset:14080
    v_mfma_f32_16x16x32_bf16 v[84:87], v[124:127], v[168:171], v[84:87]
    s_waitcnt lgkmcnt(2)
    v_mfma_f32_16x16x32_bf16 v[16:19], v[108:111], v[88:91], v[16:19]
    ds_read_b128 v[164:167], v1 offset:13312
    v_mfma_f32_16x16x32_bf16 v[16:19], v[112:115], v[160:163], v[16:19]
    v_mfma_f32_16x16x32_bf16 v[28:31], v[112:115], v[88:91], v[28:31]
    ds_read_b128 v[92:95], v1 offset:7168
    v_mfma_f32_16x16x32_bf16 v[28:31], v[116:119], v[160:163], v[28:31]
    v_mfma_f32_16x16x32_bf16 v[40:43], v[116:119], v[88:91], v[40:43]
    v_mfma_f32_16x16x32_bf16 v[40:43], v[120:123], v[160:163], v[40:43]
    s_barrier
    v_mfma_f32_16x16x32_bf16 v[52:55], v[120:123], v[88:91], v[52:55]
    v_mfma_f32_16x16x32_bf16 v[52:55], v[124:127], v[160:163], v[52:55]
    s_waitcnt lgkmcnt(3)
    v_mfma_f32_16x16x32_bf16 v[64:67], v[124:127], v[88:91], v[64:67]
    v_mfma_f32_16x16x32_bf16 v[64:67], v[128:131], v[160:163], v[64:67]
    s_waitcnt lgkmcnt(2)
    v_mfma_f32_16x16x32_bf16 v[76:79], v[128:131], v[88:91], v[76:79]
    v_mfma_f32_16x16x32_bf16 v[76:79], v[132:135], v[160:163], v[76:79]
    s_waitcnt lgkmcnt(0)
    v_mfma_f32_16x16x32_bf16 v[80:83], v[132:135], v[164:167], v[80:83]
    ds_read_b128 v[96:99], v1 offset:8192
    v_mfma_f32_16x16x32_bf16 v[80:83], v[128:131], v[92:95], v[80:83]
    v_mfma_f32_16x16x32_bf16 v[68:71], v[128:131], v[164:167], v[68:71]
    ds_read_b128 v[168:171], v1 offset:14336
    v_mfma_f32_16x16x32_bf16 v[68:71], v[124:127], v[92:95], v[68:71]
    v_mfma_f32_16x16x32_bf16 v[56:59], v[124:127], v[164:167], v[56:59]
    v_mfma_f32_16x16x32_bf16 v[56:59], v[120:123], v[92:95], v[56:59]
    v_mfma_f32_16x16x32_bf16 v[44:47], v[120:123], v[164:167], v[44:47]
    v_mfma_f32_16x16x32_bf16 v[44:47], v[116:119], v[92:95], v[44:47]
    v_mfma_f32_16x16x32_bf16 v[32:35], v[116:119], v[164:167], v[32:35]
    v_mfma_f32_16x16x32_bf16 v[32:35], v[112:115], v[92:95], v[32:35]
    v_mfma_f32_16x16x32_bf16 v[20:23], v[112:115], v[164:167], v[20:23]
    v_mfma_f32_16x16x32_bf16 v[20:23], v[108:111], v[92:95], v[20:23]
    s_barrier
    s_waitcnt lgkmcnt(0)
    v_mfma_f32_16x16x32_bf16 v[24:27], v[108:111], v[96:99], v[24:27]
    ds_read_b128 v[88:91], v1 offset:18432
    v_mfma_f32_16x16x32_bf16 v[24:27], v[112:115], v[168:171], v[24:27]
    v_mfma_f32_16x16x32_bf16 v[36:39], v[112:115], v[96:99], v[36:39]
    ds_read_b128 v[160:163], v1 offset:24576
    v_mfma_f32_16x16x32_bf16 v[36:39], v[116:119], v[168:171], v[36:39]
    v_mfma_f32_16x16x32_bf16 v[48:51], v[116:119], v[96:99], v[48:51]
    v_mfma_f32_16x16x32_bf16 v[48:51], v[120:123], v[168:171], v[48:51]
    v_mfma_f32_16x16x32_bf16 v[60:63], v[120:123], v[96:99], v[60:63]
    v_mfma_f32_16x16x32_bf16 v[60:63], v[124:127], v[168:171], v[60:63]
    v_mfma_f32_16x16x32_bf16 v[72:75], v[124:127], v[96:99], v[72:75]
    ds_read_b128 v[136:139], v152 offset:768
    v_mfma_f32_16x16x32_bf16 v[72:75], v[128:131], v[168:171], v[72:75]
    v_mfma_f32_16x16x32_bf16 v[84:87], v[128:131], v[96:99], v[84:87]
    ds_read_b128 v[140:143], v157 offset:14208
    v_mfma_f32_16x16x32_bf16 v[84:87], v[132:135], v[168:171], v[84:87]
    s_waitcnt lgkmcnt(2)
    v_mfma_f32_16x16x32_bf16 v[16:19], v[116:119], v[88:91], v[16:19]
    ds_read_b128 v[164:167], v1 offset:25600
    v_mfma_f32_16x16x32_bf16 v[16:19], v[120:123], v[160:163], v[16:19]
    v_mfma_f32_16x16x32_bf16 v[28:31], v[120:123], v[88:91], v[28:31]
    ds_read_b128 v[92:95], v1 offset:19456
    v_mfma_f32_16x16x32_bf16 v[28:31], v[124:127], v[160:163], v[28:31]
    v_mfma_f32_16x16x32_bf16 v[40:43], v[124:127], v[88:91], v[40:43]
    v_mfma_f32_16x16x32_bf16 v[40:43], v[128:131], v[160:163], v[40:43]
    s_barrier
    v_mfma_f32_16x16x32_bf16 v[52:55], v[128:131], v[88:91], v[52:55]
    v_mfma_f32_16x16x32_bf16 v[52:55], v[132:135], v[160:163], v[52:55]
    s_waitcnt lgkmcnt(3)
    v_mfma_f32_16x16x32_bf16 v[64:67], v[132:135], v[88:91], v[64:67]
    v_mfma_f32_16x16x32_bf16 v[64:67], v[136:139], v[160:163], v[64:67]
    s_waitcnt lgkmcnt(2)
    v_mfma_f32_16x16x32_bf16 v[76:79], v[136:139], v[88:91], v[76:79]
    v_mfma_f32_16x16x32_bf16 v[76:79], v[140:143], v[160:163], v[76:79]
    s_waitcnt lgkmcnt(0)
    v_mfma_f32_16x16x32_bf16 v[80:83], v[140:143], v[164:167], v[80:83]
    ds_read_b128 v[96:99], v1 offset:20480
    v_mfma_f32_16x16x32_bf16 v[80:83], v[136:139], v[92:95], v[80:83]
    v_mfma_f32_16x16x32_bf16 v[68:71], v[136:139], v[164:167], v[68:71]
    ds_read_b128 v[168:171], v1 offset:26624
    v_mfma_f32_16x16x32_bf16 v[68:71], v[132:135], v[92:95], v[68:71]
    v_mfma_f32_16x16x32_bf16 v[56:59], v[132:135], v[164:167], v[56:59]
    v_mfma_f32_16x16x32_bf16 v[56:59], v[128:131], v[92:95], v[56:59]
    v_mfma_f32_16x16x32_bf16 v[44:47], v[128:131], v[164:167], v[44:47]
    v_mfma_f32_16x16x32_bf16 v[44:47], v[124:127], v[92:95], v[44:47]
    v_mfma_f32_16x16x32_bf16 v[32:35], v[124:127], v[164:167], v[32:35]
    v_mfma_f32_16x16x32_bf16 v[32:35], v[120:123], v[92:95], v[32:35]
    v_mfma_f32_16x16x32_bf16 v[20:23], v[120:123], v[164:167], v[20:23]
    v_mfma_f32_16x16x32_bf16 v[20:23], v[116:119], v[92:95], v[20:23]
    s_barrier
    s_waitcnt lgkmcnt(0)
    v_mfma_f32_16x16x32_bf16 v[24:27], v[116:119], v[96:99], v[24:27]
    ds_read_b128 v[88:91], v1 offset:30720
    v_mfma_f32_16x16x32_bf16 v[24:27], v[120:123], v[168:171], v[24:27]
    v_mfma_f32_16x16x32_bf16 v[36:39], v[120:123], v[96:99], v[36:39]
    ds_read_b128 v[160:163], v1 offset:36864
    v_mfma_f32_16x16x32_bf16 v[36:39], v[124:127], v[168:171], v[36:39]
    v_mfma_f32_16x16x32_bf16 v[48:51], v[124:127], v[96:99], v[48:51]
    v_mfma_f32_16x16x32_bf16 v[48:51], v[128:131], v[168:171], v[48:51]
    v_mfma_f32_16x16x32_bf16 v[60:63], v[128:131], v[96:99], v[60:63]
    v_mfma_f32_16x16x32_bf16 v[60:63], v[132:135], v[168:171], v[60:63]
    v_mfma_f32_16x16x32_bf16 v[72:75], v[132:135], v[96:99], v[72:75]
    ds_read_b128 v[144:147], v153 offset:896
    v_mfma_f32_16x16x32_bf16 v[72:75], v[136:139], v[168:171], v[72:75]
    v_mfma_f32_16x16x32_bf16 v[84:87], v[136:139], v[96:99], v[84:87]
    ds_read_b128 v[148:151], v158 offset:14336
    v_mfma_f32_16x16x32_bf16 v[84:87], v[140:143], v[168:171], v[84:87]
    s_waitcnt lgkmcnt(2)
    v_mfma_f32_16x16x32_bf16 v[16:19], v[124:127], v[88:91], v[16:19]
    ds_read_b128 v[164:167], v1 offset:37888
    v_mfma_f32_16x16x32_bf16 v[16:19], v[128:131], v[160:163], v[16:19]
    v_mfma_f32_16x16x32_bf16 v[28:31], v[128:131], v[88:91], v[28:31]
    ds_read_b128 v[92:95], v1 offset:31744
    v_mfma_f32_16x16x32_bf16 v[28:31], v[132:135], v[160:163], v[28:31]
    v_mfma_f32_16x16x32_bf16 v[40:43], v[132:135], v[88:91], v[40:43]
    v_mfma_f32_16x16x32_bf16 v[40:43], v[136:139], v[160:163], v[40:43]
    s_barrier
L_pad_m2:
    s_cbranch_scc1 L_ret
    v_mfma_f32_16x16x32_bf16 v[52:55], v[136:139], v[88:91], v[52:55]
    v_mfma_f32_16x16x32_bf16 v[52:55], v[140:143], v[160:163], v[52:55]
    s_waitcnt lgkmcnt(3)
    v_mfma_f32_16x16x32_bf16 v[64:67], v[140:143], v[88:91], v[64:67]
    v_mfma_f32_16x16x32_bf16 v[64:67], v[144:147], v[160:163], v[64:67]
    s_waitcnt lgkmcnt(2)
    v_mfma_f32_16x16x32_bf16 v[76:79], v[144:147], v[88:91], v[76:79]
    v_mfma_f32_16x16x32_bf16 v[76:79], v[148:151], v[160:163], v[76:79]
    s_waitcnt lgkmcnt(0)
    v_mfma_f32_16x16x32_bf16 v[80:83], v[148:151], v[164:167], v[80:83]
    ds_read_b128 v[96:99], v1 offset:32768
    v_mfma_f32_16x16x32_bf16 v[80:83], v[144:147], v[92:95], v[80:83]
    v_mfma_f32_16x16x32_bf16 v[68:71], v[144:147], v[164:167], v[68:71]
    ds_read_b128 v[168:171], v1 offset:38912
    v_mfma_f32_16x16x32_bf16 v[68:71], v[140:143], v[92:95], v[68:71]
    v_mfma_f32_16x16x32_bf16 v[56:59], v[140:143], v[164:167], v[56:59]
    v_mfma_f32_16x16x32_bf16 v[56:59], v[136:139], v[92:95], v[56:59]
    v_mfma_f32_16x16x32_bf16 v[44:47], v[136:139], v[164:167], v[44:47]
    v_mfma_f32_16x16x32_bf16 v[44:47], v[132:135], v[92:95], v[44:47]
    v_mfma_f32_16x16x32_bf16 v[32:35], v[132:135], v[164:167], v[32:35]
    v_mfma_f32_16x16x32_bf16 v[32:35], v[128:131], v[92:95], v[32:35]
    v_mfma_f32_16x16x32_bf16 v[20:23], v[128:131], v[164:167], v[20:23]
    v_mfma_f32_16x16x32_bf16 v[20:23], v[124:127], v[92:95], v[20:23]
    s_barrier
    s_waitcnt lgkmcnt(0)
    v_mfma_f32_16x16x32_bf16 v[24:27], v[124:127], v[96:99], v[24:27]
    ds_read_b128 v[88:91], v1 offset:43008
    v_mfma_f32_16x16x32_bf16 v[24:27], v[128:131], v[168:171], v[24:27]
    v_mfma_f32_16x16x32_bf16 v[36:39], v[128:131], v[96:99], v[36:39]
    ds_read_b128 v[100:103], v156 offset:13568
    v_mfma_f32_16x16x32_bf16 v[36:39], v[132:135], v[168:171], v[36:39]
    v_mfma_f32_16x16x32_bf16 v[48:51], v[132:135], v[96:99], v[48:51]
    ds_read_b128 v[160:163], v1 offset:49152
    v_mfma_f32_16x16x32_bf16 v[48:51], v[136:139], v[168:171], v[48:51]
    v_mfma_f32_16x16x32_bf16 v[60:63], v[136:139], v[96:99], v[60:63]
    ds_read_b128 v[104:107], v152 offset:26880
    v_mfma_f32_16x16x32_bf16 v[60:63], v[140:143], v[168:171], v[60:63]
    v_mfma_f32_16x16x32_bf16 v[72:75], v[140:143], v[96:99], v[72:75]
    ds_read_b128 v[108:111], v157 offset:13696
    v_mfma_f32_16x16x32_bf16 v[72:75], v[144:147], v[168:171], v[72:75]
    v_mfma_f32_16x16x32_bf16 v[84:87], v[144:147], v[96:99], v[84:87]
    ds_read_b128 v[112:115], v153 offset:27008
    v_mfma_f32_16x16x32_bf16 v[84:87], v[148:151], v[168:171], v[84:87]
    s_waitcnt lgkmcnt(2)
    v_mfma_f32_16x16x32_bf16 v[16:19], v[100:103], v[88:91], v[16:19]
    ds_read_b128 v[116:119], v158 offset:13824
    v_mfma_f32_16x16x32_bf16 v[16:19], v[104:107], v[160:163], v[16:19]
    s_waitcnt lgkmcnt(2)
    v_mfma_f32_16x16x32_bf16 v[28:31], v[104:107], v[88:91], v[28:31]
    ds_read_b128 v[120:123], v154 offset:27136
    v_mfma_f32_16x16x32_bf16 v[28:31], v[108:111], v[160:163], v[28:31]
    s_waitcnt lgkmcnt(2)
    v_mfma_f32_16x16x32_bf16 v[40:43], v[108:111], v[88:91], v[40:43]
    ds_read_b128 v[124:127], v159 offset:13952
    v_mfma_f32_16x16x32_bf16 v[40:43], v[112:115], v[160:163], v[40:43]
    s_barrier
    ds_read_b128 v[164:167], v1 offset:50176
    s_waitcnt lgkmcnt(3)
    v_mfma_f32_16x16x32_bf16 v[52:55], v[112:115], v[88:91], v[52:55]
    ds_read_b128 v[92:95], v1 offset:44032
    v_mfma_f32_16x16x32_bf16 v[52:55], v[116:119], v[160:163], v[52:55]
    s_waitcnt lgkmcnt(3)
    v_mfma_f32_16x16x32_bf16 v[64:67], v[116:119], v[88:91], v[64:67]
    v_mfma_f32_16x16x32_bf16 v[64:67], v[120:123], v[160:163], v[64:67]
    s_waitcnt lgkmcnt(2)
    v_mfma_f32_16x16x32_bf16 v[76:79], v[120:123], v[88:91], v[76:79]
    v_mfma_f32_16x16x32_bf16 v[76:79], v[124:127], v[160:163], v[76:79]
    s_waitcnt lgkmcnt(0)
    v_mfma_f32_16x16x32_bf16 v[80:83], v[124:127], v[164:167], v[80:83]
    ds_read_b128 v[96:99], v1 offset:45056
    v_mfma_f32_16x16x32_bf16 v[80:83], v[120:123], v[92:95], v[80:83]
    v_mfma_f32_16x16x32_bf16 v[68:71], v[120:123], v[164:167], v[68:71]
    ds_read_b128 v[168:171], v1 offset:51200
    v_mfma_f32_16x16x32_bf16 v[68:71], v[116:119], v[92:95], v[68:71]
    v_mfma_f32_16x16x32_bf16 v[56:59], v[116:119], v[164:167], v[56:59]
    v_mfma_f32_16x16x32_bf16 v[56:59], v[112:115], v[92:95], v[56:59]
    v_mfma_f32_16x16x32_bf16 v[44:47], v[112:115], v[164:167], v[44:47]
    v_mfma_f32_16x16x32_bf16 v[44:47], v[108:111], v[92:95], v[44:47]
    v_mfma_f32_16x16x32_bf16 v[32:35], v[108:111], v[164:167], v[32:35]
    v_mfma_f32_16x16x32_bf16 v[32:35], v[104:107], v[92:95], v[32:35]
    v_mfma_f32_16x16x32_bf16 v[20:23], v[104:107], v[164:167], v[20:23]
    v_mfma_f32_16x16x32_bf16 v[20:23], v[100:103], v[92:95], v[20:23]
    s_barrier
    s_waitcnt lgkmcnt(0)
    v_mfma_f32_16x16x32_bf16 v[24:27], v[100:103], v[96:99], v[24:27]
    ds_read_b128 v[88:91], v1 offset:55296
    v_mfma_f32_16x16x32_bf16 v[24:27], v[104:107], v[168:171], v[24:27]
    v_mfma_f32_16x16x32_bf16 v[36:39], v[104:107], v[96:99], v[36:39]
    ds_read_b128 v[160:163], v1 offset:61440
    v_mfma_f32_16x16x32_bf16 v[36:39], v[108:111], v[168:171], v[36:39]
    v_mfma_f32_16x16x32_bf16 v[48:51], v[108:111], v[96:99], v[48:51]
    v_mfma_f32_16x16x32_bf16 v[48:51], v[112:115], v[168:171], v[48:51]
    v_mfma_f32_16x16x32_bf16 v[60:63], v[112:115], v[96:99], v[60:63]
    v_mfma_f32_16x16x32_bf16 v[60:63], v[116:119], v[168:171], v[60:63]
    v_mfma_f32_16x16x32_bf16 v[72:75], v[116:119], v[96:99], v[72:75]
    ds_read_b128 v[128:131], v155 offset:27264
    v_mfma_f32_16x16x32_bf16 v[72:75], v[120:123], v[168:171], v[72:75]
    v_mfma_f32_16x16x32_bf16 v[84:87], v[120:123], v[96:99], v[84:87]
    ds_read_b128 v[132:135], v152 offset:14080
    v_mfma_f32_16x16x32_bf16 v[84:87], v[124:127], v[168:171], v[84:87]
    s_waitcnt lgkmcnt(2)
    v_mfma_f32_16x16x32_bf16 v[16:19], v[108:111], v[88:91], v[16:19]
    ds_read_b128 v[164:167], v1 offset:62464
    v_mfma_f32_16x16x32_bf16 v[16:19], v[112:115], v[160:163], v[16:19]
    v_mfma_f32_16x16x32_bf16 v[28:31], v[112:115], v[88:91], v[28:31]
    ds_read_b128 v[92:95], v1 offset:56320
    v_mfma_f32_16x16x32_bf16 v[28:31], v[116:119], v[160:163], v[28:31]
    v_mfma_f32_16x16x32_bf16 v[40:43], v[116:119], v[88:91], v[40:43]
    v_mfma_f32_16x16x32_bf16 v[40:43], v[120:123], v[160:163], v[40:43]
    s_barrier
    v_mfma_f32_16x16x32_bf16 v[52:55], v[120:123], v[88:91], v[52:55]
    v_mfma_f32_16x16x32_bf16 v[52:55], v[124:127], v[160:163], v[52:55]
    s_waitcnt lgkmcnt(3)
    v_mfma_f32_16x16x32_bf16 v[64:67], v[124:127], v[88:91], v[64:67]
    v_mfma_f32_16x16x32_bf16 v[64:67], v[128:131], v[160:163], v[64:67]
    s_waitcnt lgkmcnt(2)
    v_mfma_f32_16x16x32_bf16 v[76:79], v[128:131], v[88:91], v[76:79]
    v_mfma_f32_16x16x32_bf16 v[76:79], v[132:135], v[160:163], v[76:79]
    s_waitcnt lgkmcnt(0)
    v_mfma_f32_16x16x32_bf16 v[80:83], v[132:135], v[164:167], v[80:83]
    ds_read_b128 v[96:99], v1 offset:57344
    v_mfma_f32_16x16x32_bf16 v[80:83], v[128:131], v[92:95], v[80:83]
    v_mfma_f32_16x16x32_bf16 v[68:71], v[128:131], v[164:167], v[68:71]
    ds_read_b128 v[168:171], v1 offset:63488
    v_mfma_f32_16x16x32_bf16 v[68:71], v[124:127], v[92:95], v[68:71]
    v_mfma_f32_16x16x32_bf16 v[56:59], v[124:127], v[164:167], v[56:59]
    v_mfma_f32_16x16x32_bf16 v[56:59], v[120:123], v[92:95], v[56:59]
    v_mfma_f32_16x16x32_bf16 v[44:47], v[120:123], v[164:167], v[44:47]
    v_mfma_f32_16x16x32_bf16 v[44:47], v[116:119], v[92:95], v[44:47]
    v_mfma_f32_16x16x32_bf16 v[32:35], v[116:119], v[164:167], v[32:35]
    v_mfma_f32_16x16x32_bf16 v[32:35], v[112:115], v[92:95], v[32:35]
    v_mfma_f32_16x16x32_bf16 v[20:23], v[112:115], v[164:167], v[20:23]
    v_mfma_f32_16x16x32_bf16 v[20:23], v[108:111], v[92:95], v[20:23]
    s_barrier
    s_waitcnt lgkmcnt(0)
    v_mfma_f32_16x16x32_bf16 v[24:27], v[108:111], v[96:99], v[24:27]
    ds_read_b128 v[88:91], v1 offset:0
    v_mfma_f32_16x16x32_bf16 v[24:27], v[112:115], v[168:171], v[24:27]
    v_mfma_f32_16x16x32_bf16 v[36:39], v[112:115], v[96:99], v[36:39]
    ds_read_b128 v[160:163], v1 offset:6144
    v_mfma_f32_16x16x32_bf16 v[36:39], v[116:119], v[168:171], v[36:39]
    v_mfma_f32_16x16x32_bf16 v[48:51], v[116:119], v[96:99], v[48:51]
    s_cbranch_vccnz L_s_k1
    v_mfma_f32_16x16x32_bf16 v[48:51], v[120:123], v[168:171], v[48:51]
    v_mfma_f32_16x16x32_bf16 v[60:63], v[120:123], v[96:99], v[60:63]
    v_mfma_f32_16x16x32_bf16 v[60:63], v[124:127], v[168:171], v[60:63]
    v_mfma_f32_16x16x32_bf16 v[72:75], v[124:127], v[96:99], v[72:75]
    ds_read_b128 v[136:139], v156 offset:27392
    v_mfma_f32_16x16x32_bf16 v[72:75], v[128:131], v[168:171], v[72:75]
    v_mfma_f32_16x16x32_bf16 v[84:87], v[128:131], v[96:99], v[84:87]
    ds_read_b128 v[140:143], v153 offset:14208
    v_mfma_f32_16x16x32_bf16 v[84:87], v[132:135], v[168:171], v[84:87]
    s_waitcnt lgkmcnt(2)
    v_mfma_f32_16x16x32_bf16 v[16:19], v[116:119], v[88:91], v[16:19]
    ds_read_b128 v[164:167], v1 offset:7168
    v_mfma_f32_16x16x32_bf16 v[16:19], v[120:123], v[160:163], v[16:19]
    v_mfma_f32_16x16x32_bf16 v[28:31], v[120:123], v[88:91], v[28:31]
    ds_read_b128 v[92:95], v1 offset:1024
    v_mfma_f32_16x16x32_bf16 v[28:31], v[124:127], v[160:163], v[28:31]
    v_mfma_f32_16x16x32_bf16 v[40:43], v[124:127], v[88:91], v[40:43]
    v_mfma_f32_16x16x32_bf16 v[40:43], v[128:131], v[160:163], v[40:43]
    s_barrier
    v_mfma_f32_16x16x32_bf16 v[52:55], v[128:131], v[88:91], v[52:55]
    v_mfma_f32_16x16x32_bf16 v[52:55], v[132:135], v[160:163], v[52:55]
    s_waitcnt lgkmcnt(3)
    v_mfma_f32_16x16x32_bf16 v[64:67], v[132:135], v[88:91], v[64:67]
    v_mfma_f32_16x16x32_bf16 v[64:67], v[136:139], v[160:163], v[64:67]
    s_waitcnt lgkmcnt(2)
    v_mfma_f32_16x16x32_bf16 v[76:79], v[136:139], v[88:91], v[76:79]
    v_mfma_f32_16x16x32_bf16 v[76:79], v[140:143], v[160:163], v[76:79]
    s_waitcnt lgkmcnt(0)
    v_mfma_f32_16x16x32_bf16 v[80:83], v[140:143], v[164:167], v[80:83]
    ds_read_b128 v[96:99], v1 offset:2048
    v_mfma_f32_16x16x32_bf16 v[80:83], v[136:139], v[92:95], v[80:83]
    v_mfma_f32_16x16x32_bf16 v[68:71], v[136:139], v[164:167], v[68:71]
    ds_read_b128 v[168:171], v1 offset:8192
    v_mfma_f32_16x16x32_bf16 v[68:71], v[132:135], v[92:95], v[68:71]
    v_mfma_f32_16x16x32_bf16 v[56:59], v[132:135], v[164:167], v[56:59]
    v_mfma_f32_16x16x32_bf16 v[56:59], v[128:131], v[92:95], v[56:59]
    v_mfma_f32_16x16x32_bf16 v[44:47], v[128:131], v[164:167], v[44:47]
    v_mfma_f32_16x16x32_bf16 v[44:47], v[124:127], v[92:95], v[44:47]
    v_mfma_f32_16x16x32_bf16 v[32:35], v[124:127], v[164:167], v[32:35]
    v_mfma_f32_16x16x32_bf16 v[32:35], v[120:123], v[92:95], v[32:35]
    v_mfma_f32_16x16x32_bf16 v[20:23], v[120:123], v[164:167], v[20:23]
    v_mfma_f32_16x16x32_bf16 v[20:23], v[116:119], v[92:95], v[20:23]
    s_barrier
    s_waitcnt lgkmcnt(0)
    v_mfma_f32_16x16x32_bf16 v[24:27], v[116:119], v[96:99], v[24:27]
    ds_read_b128 v[88:91], v1 offset:12288
    v_mfma_f32_16x16x32_bf16 v[24:27], v[120:123], v[168:171], v[24:27]
    v_mfma_f32_16x16x32_bf16 v[36:39], v[120:123], v[96:99], v[36:39]
    ds_read_b128 v[160:163], v1 offset:18432
    v_mfma_f32_16x16x32_bf16 v[36:39], v[124:127], v[168:171], v[36:39]
    v_mfma_f32_16x16x32_bf16 v[48:51], v[124:127], v[96:99], v[48:51]
    v_mfma_f32_16x16x32_bf16 v[48:51], v[128:131], v[168:171], v[48:51]
    v_mfma_f32_16x16x32_bf16 v[60:63], v[128:131], v[96:99], v[60:63]
    v_mfma_f32_16x16x32_bf16 v[60:63], v[132:135], v[168:171], v[60:63]
    v_mfma_f32_16x16x32_bf16 v[72:75], v[132:135], v[96:99], v[72:75]
    ds_read_b128 v[144:147], v157 offset:27520
    v_mfma_f32_16x16x32_bf16 v[72:75], v[136:139], v[168:171], v[72:75]
    v_mfma_f32_16x16x32_bf16 v[84:87], v[136:139], v[96:99], v[84:87]
    ds_read_b128 v[148:151], v154 offset:14336
    v_mfma_f32_16x16x32_bf16 v[84:87], v[140:143], v[168:171], v[84:87]
    s_waitcnt lgkmcnt(2)
    v_mfma_f32_16x16x32_bf16 v[16:19], v[124:127], v[88:91], v[16:19]
    ds_read_b128 v[164:167], v1 offset:19456
    v_mfma_f32_16x16x32_bf16 v[16:19], v[128:131], v[160:163], v[16:19]
    v_mfma_f32_16x16x32_bf16 v[28:31], v[128:131], v[88:91], v[28:31]
    ds_read_b128 v[92:95], v1 offset:13312
    v_mfma_f32_16x16x32_bf16 v[28:31], v[132:135], v[160:163], v[28:31]
    v_mfma_f32_16x16x32_bf16 v[40:43], v[132:135], v[88:91], v[40:43]
    v_mfma_f32_16x16x32_bf16 v[40:43], v[136:139], v[160:163], v[40:43]
    s_barrier
    v_mfma_f32_16x16x32_bf16 v[52:55], v[136:139], v[88:91], v[52:55]
    v_mfma_f32_16x16x32_bf16 v[52:55], v[140:143], v[160:163], v[52:55]
    s_waitcnt lgkmcnt(3)
    v_mfma_f32_16x16x32_bf16 v[64:67], v[140:143], v[88:91], v[64:67]
    v_mfma_f32_16x16x32_bf16 v[64:67], v[144:147], v[160:163], v[64:67]
    s_waitcnt lgkmcnt(2)
    v_mfma_f32_16x16x32_bf16 v[76:79], v[144:147], v[88:91], v[76:79]
    v_mfma_f32_16x16x32_bf16 v[76:79], v[148:151], v[160:163], v[76:79]
    s_waitcnt lgkmcnt(0)
    v_mfma_f32_16x16x32_bf16 v[80:83], v[148:151], v[164:167], v[80:83]
    ds_read_b128 v[96:99], v1 offset:14336
    v_mfma_f32_16x16x32_bf16 v[80:83], v[144:147], v[92:95], v[80:83]
    v_mfma_f32_16x16x32_bf16 v[68:71], v[144:147], v[164:167], v[68:71]
    ds_read_b128 v[168:171], v1 offset:20480
    v_mfma_f32_16x16x32_bf16 v[68:71], v[140:143], v[92:95], v[68:71]
    v_mfma_f32_16x16x32_bf16 v[56:59], v[140:143], v[164:167], v[56:59]
    v_mfma_f32_16x16x32_bf16 v[56:59], v[136:139], v[92:95], v[56:59]
    v_mfma_f32_16x16x32_bf16 v[44:47], v[136:139], v[164:167], v[44:47]
    v_mfma_f32_16x16x32_bf16 v[44:47], v[132:135], v[92:95], v[44:47]
    v_mfma_f32_16x16x32_bf16 v[32:35], v[132:135], v[164:167], v[32:35]
    v_mfma_f32_16x16x32_bf16 v[32:35], v[128:131], v[92:95], v[32:35]
    v_mfma_f32_16x16x32_bf16 v[20:23], v[128:131], v[164:167], v[20:23]
    v_mfma_f32_16x16x32_bf16 v[20:23], v[124:127], v[92:95], v[20:23]
    s_barrier
    s_waitcnt lgkmcnt(0)
    v_mfma_f32_16x16x32_bf16 v[24:27], v[124:127], v[96:99], v[24:27]
    ds_read_b128 v[88:91], v1 offset:24576
    v_mfma_f32_16x16x32_bf16 v[24:27], v[128:131], v[168:171], v[24:27]
    v_mfma_f32_16x16x32_bf16 v[36:39], v[128:131], v[96:99], v[36:39]
    ds_read_b128 v[100:103], v152 offset:40192
    v_mfma_f32_16x16x32_bf16 v[36:39], v[132:135], v[168:171], v[36:39]
    v_mfma_f32_16x16x32_bf16 v[48:51], v[132:135], v[96:99], v[48:51]
    ds_read_b128 v[160:163], v1 offset:30720
    v_mfma_f32_16x16x32_bf16 v[48:51], v[136:139], v[168:171], v[48:51]
    v_mfma_f32_16x16x32_bf16 v[60:63], v[136:139], v[96:99], v[60:63]
    ds_read_b128 v[104:107], v156 offset:26880
    v_mfma_f32_16x16x32_bf16 v[60:63], v[140:143], v[168:171], v[60:63]
    v_mfma_f32_16x16x32_bf16 v[72:75], v[140:143], v[96:99], v[72:75]
    ds_read_b128 v[108:111], v153 offset:40320
    v_mfma_f32_16x16x32_bf16 v[72:75], v[144:147], v[168:171], v[72:75]
    v_mfma_f32_16x16x32_bf16 v[84:87], v[144:147], v[96:99], v[84:87]
    ds_read_b128 v[112:115], v157 offset:27008
    v_mfma_f32_16x16x32_bf16 v[84:87], v[148:151], v[168:171], v[84:87]
    s_waitcnt lgkmcnt(2)
    v_mfma_f32_16x16x32_bf16 v[16:19], v[100:103], v[88:91], v[16:19]
    ds_read_b128 v[116:119], v154 offset:40448
    v_mfma_f32_16x16x32_bf16 v[16:19], v[104:107], v[160:163], v[16:19]
    s_waitcnt lgkmcnt(2)
    v_mfma_f32_16x16x32_bf16 v[28:31], v[104:107], v[88:91], v[28:31]
    ds_read_b128 v[120:123], v158 offset:27136
    v_mfma_f32_16x16x32_bf16 v[28:31], v[108:111], v[160:163], v[28:31]
    s_waitcnt lgkmcnt(2)
    v_mfma_f32_16x16x32_bf16 v[40:43], v[108:111], v[88:91], v[40:43]
    ds_read_b128 v[124:127], v155 offset:40576
    v_mfma_f32_16x16x32_bf16 v[40:43], v[112:115], v[160:163], v[40:43]
    s_barrier
    ds_read_b128 v[164:167], v1 offset:31744
    s_waitcnt lgkmcnt(3)
    v_mfma_f32_16x16x32_bf16 v[52:55], v[112:115], v[88:91], v[52:55]
    ds_read_b128 v[92:95], v1 offset:25600
    v_mfma_f32_16x16x32_bf16 v[52:55], v[116:119], v[160:163], v[52:55]
    s_waitcnt lgkmcnt(3)
    v_mfma_f32_16x16x32_bf16 v[64:67], v[116:119], v[88:91], v[64:67]
    v_mfma_f32_16x16x32_bf16 v[64:67], v[120:123], v[160:163], v[64:67]
    s_waitcnt lgkmcnt(2)
    v_mfma_f32_16x16x32_bf16 v[76:79], v[120:123], v[88:91], v[76:79]
    v_mfma_f32_16x16x32_bf16 v[76:79], v[124:127], v[160:163], v[76:79]
    s_waitcnt lgkmcnt(0)
    v_mfma_f32_16x16x32_bf16 v[80:83], v[124:127], v[164:167], v[80:83]
    ds_read_b128 v[96:99], v1 offset:26624
    v_mfma_f32_16x16x32_bf16 v[80:83], v[120:123], v[92:95], v[80:83]
    v_mfma_f32_16x16x32_bf16 v[68:71], v[120:123], v[164:167], v[68:71]
    ds_read_b128 v[168:171], v1 offset:32768
    v_mfma_f32_16x16x32_bf16 v[68:71], v[116:119], v[92:95], v[68:71]
    v_mfma_f32_16x16x32_bf16 v[56:59], v[116:119], v[164:167], v[56:59]
    v_mfma_f32_16x16x32_bf16 v[56:59], v[112:115], v[92:95], v[56:59]
    v_mfma_f32_16x16x32_bf16 v[44:47], v[112:115], v[164:167], v[44:47]
    v_mfma_f32_16x16x32_bf16 v[44:47], v[108:111], v[92:95], v[44:47]
    v_mfma_f32_16x16x32_bf16 v[32:35], v[108:111], v[164:167], v[32:35]
    v_mfma_f32_16x16x32_bf16 v[32:35], v[104:107], v[92:95], v[32:35]
    v_mfma_f32_16x16x32_bf16 v[20:23], v[104:107], v[164:167], v[20:23]
    v_mfma_f32_16x16x32_bf16 v[20:23], v[100:103], v[92:95], v[20:23]
    s_barrier
    s_waitcnt lgkmcnt(0)
    v_mfma_f32_16x16x32_bf16 v[24:27], v[100:103], v[96:99], v[24:27]
    ds_read_b128 v[88:91], v1 offset:36864
    v_mfma_f32_16x16x32_bf16 v[24:27], v[104:107], v[168:171], v[24:27]
    v_mfma_f32_16x16x32_bf16 v[36:39], v[104:107], v[96:99], v[36:39]
    ds_read_b128 v[160:163], v1 offset:43008
    v_mfma_f32_16x16x32_bf16 v[36:39], v[108:111], v[168:171], v[36:39]
    v_mfma_f32_16x16x32_bf16 v[48:51], v[108:111], v[96:99], v[48:51]
    v_mfma_f32_16x16x32_bf16 v[48:51], v[112:115], v[168:171], v[48:51]
    v_mfma_f32_16x16x32_bf16 v[60:63], v[112:115], v[96:99], v[60:63]
    v_mfma_f32_16x16x32_bf16 v[60:63], v[116:119], v[168:171], v[60:63]
    v_mfma_f32_16x16x32_bf16 v[72:75], v[116:119], v[96:99], v[72:75]
    ds_read_b128 v[128:131], v159 offset:27264
    v_mfma_f32_16x16x32_bf16 v[72:75], v[120:123], v[168:171], v[72:75]
    v_mfma_f32_16x16x32_bf16 v[84:87], v[120:123], v[96:99], v[84:87]
    ds_read_b128 v[132:135], v156 offset:40704
    v_mfma_f32_16x16x32_bf16 v[84:87], v[124:127], v[168:171], v[84:87]
    s_waitcnt lgkmcnt(2)
    v_mfma_f32_16x16x32_bf16 v[16:19], v[108:111], v[88:91], v[16:19]
    ds_read_b128 v[164:167], v1 offset:44032
    v_mfma_f32_16x16x32_bf16 v[16:19], v[112:115], v[160:163], v[16:19]
    v_mfma_f32_16x16x32_bf16 v[28:31], v[112:115], v[88:91], v[28:31]
    ds_read_b128 v[92:95], v1 offset:37888
    v_mfma_f32_16x16x32_bf16 v[28:31], v[116:119], v[160:163], v[28:31]
    v_mfma_f32_16x16x32_bf16 v[40:43], v[116:119], v[88:91], v[40:43]
    v_mfma_f32_16x16x32_bf16 v[40:43], v[120:123], v[160:163], v[40:43]
    s_barrier
    v_mfma_f32_16x16x32_bf16 v[52:55], v[120:123], v[88:91], v[52:55]
    v_mfma_f32_16x16x32_bf16 v[52:55], v[124:127], v[160:163], v[52:55]
    s_waitcnt lgkmcnt(3)
    v_mfma_f32_16x16x32_bf16 v[64:67], v[124:127], v[88:91], v[64:67]
    v_mfma_f32_16x16x32_bf16 v[64:67], v[128:131], v[160:163], v[64:67]
    s_waitcnt lgkmcnt(2)
    v_mfma_f32_16x16x32_bf16 v[76:79], v[128:131], v[88:91], v[76:79]
    v_mfma_f32_16x16x32_bf16 v[76:79], v[132:135], v[160:163], v[76:79]
    s_waitcnt lgkmcnt(0)
    v_mfma_f32_16x16x32_bf16 v[80:83], v[132:135], v[164:167], v[80:83]
    ds_read_b128 v[96:99], v1 offset:38912
    v_mfma_f32_16x16x32_bf16 v[80:83], v[128:131], v[92:95], v[80:83]
    v_mfma_f32_16x16x32_bf16 v[68:71], v[128:131], v[164:167], v[68:71]
    ds_read_b128 v[168:171], v1 offset:45056
    v_mfma_f32_16x16x32_bf16 v[68:71], v[124:127], v[92:95], v[68:71]
    v_mfma_f32_16x16x32_bf16 v[56:59], v[124:127], v[164:167], v[56:59]
    v_mfma_f32_16x16x32_bf16 v[56:59], v[120:123], v[92:95], v[56:59]
    v_mfma_f32_16x16x32_bf16 v[44:47], v[120:123], v[164:167], v[44:47]
    v_mfma_f32_16x16x32_bf16 v[44:47], v[116:119], v[92:95], v[44:47]
    v_mfma_f32_16x16x32_bf16 v[32:35], v[116:119], v[164:167], v[32:35]
    v_mfma_f32_16x16x32_bf16 v[32:35], v[112:115], v[92:95], v[32:35]
    v_mfma_f32_16x16x32_bf16 v[20:23], v[112:115], v[164:167], v[20:23]
    v_mfma_f32_16x16x32_bf16 v[20:23], v[108:111], v[92:95], v[20:23]
    s_barrier
    s_waitcnt lgkmcnt(0)
    v_mfma_f32_16x16x32_bf16 v[24:27], v[108:111], v[96:99], v[24:27]
    ds_read_b128 v[88:91], v1 offset:49152
    v_mfma_f32_16x16x32_bf16 v[24:27], v[112:115], v[168:171], v[24:27]
    v_mfma_f32_16x16x32_bf16 v[36:39], v[112:115], v[96:99], v[36:39]
    ds_read_b128 v[160:163], v1 offset:55296
    v_mfma_f32_16x16x32_bf16 v[36:39], v[116:119], v[168:171], v[36:39]
    v_mfma_f32_16x16x32_bf16 v[48:51], v[116:119], v[96:99], v[48:51]
    ds_read_b128 v[172:175], v1 offset:61440
    v_mfma_f32_16x16x32_bf16 v[48:51], v[120:123], v[168:171], v[48:51]
    v_mfma_f32_16x16x32_bf16 v[60:63], v[120:123], v[96:99], v[60:63]
    v_mfma_f32_16x16x32_bf16 v[60:63], v[124:127], v[168:171], v[60:63]
    v_mfma_f32_16x16x32_bf16 v[72:75], v[124:127], v[96:99], v[72:75]
    ds_read_b128 v[136:139], v152 offset:27392
    v_mfma_f32_16x16x32_bf16 v[72:75], v[128:131], v[168:171], v[72:75]
    v_mfma_f32_16x16x32_bf16 v[84:87], v[128:131], v[96:99], v[84:87]
    v_mfma_f32_16x16x32_bf16 v[84:87], v[132:135], v[168:171], v[84:87]
    s_waitcnt lgkmcnt(2)
    v_mfma_f32_16x16x32_bf16 v[16:19], v[116:119], v[88:91], v[16:19]
    s_waitcnt lgkmcnt(1)
    v_mfma_f32_16x16x32_bf16 v[16:19], v[120:123], v[160:163], v[16:19]
    ds_read_b128 v[140:143], v157 offset:40832
    v_mfma_f32_16x16x32_bf16 v[16:19], v[124:127], v[172:175], v[16:19]
    v_mfma_f32_16x16x32_bf16 v[28:31], v[128:131], v[172:175], v[28:31]
    ds_read_b128 v[144:147], v153 offset:27520
    v_mfma_f32_16x16x32_bf16 v[28:31], v[124:127], v[160:163], v[28:31]
    v_mfma_f32_16x16x32_bf16 v[28:31], v[120:123], v[88:91], v[28:31]
    s_barrier
    v_mfma_f32_16x16x32_bf16 v[40:43], v[124:127], v[88:91], v[40:43]
    ds_read_b128 v[92:95], v1 offset:50176
    v_mfma_f32_16x16x32_bf16 v[40:43], v[128:131], v[160:163], v[40:43]
    ds_read_b128 v[164:167], v1 offset:56320
    v_mfma_f32_16x16x32_bf16 v[40:43], v[132:135], v[172:175], v[40:43]
    s_waitcnt lgkmcnt(4)
    v_mfma_f32_16x16x32_bf16 v[52:55], v[136:139], v[172:175], v[52:55]
    ds_read_b128 v[176:179], v1 offset:62464
    v_mfma_f32_16x16x32_bf16 v[52:55], v[132:135], v[160:163], v[52:55]
    v_mfma_f32_16x16x32_bf16 v[52:55], v[128:131], v[88:91], v[52:55]
    v_mfma_f32_16x16x32_bf16 v[64:67], v[132:135], v[88:91], v[64:67]
    s_waitcnt lgkmcnt(4)
    v_mfma_f32_16x16x32_bf16 v[64:67], v[136:139], v[160:163], v[64:67]
    v_mfma_f32_16x16x32_bf16 v[64:67], v[140:143], v[172:175], v[64:67]
    s_waitcnt lgkmcnt(3)
    v_mfma_f32_16x16x32_bf16 v[76:79], v[144:147], v[172:175], v[76:79]
    v_mfma_f32_16x16x32_bf16 v[76:79], v[140:143], v[160:163], v[76:79]
    v_mfma_f32_16x16x32_bf16 v[76:79], v[136:139], v[88:91], v[76:79]
    s_waitcnt lgkmcnt(1)
    v_mfma_f32_16x16x32_bf16 v[80:83], v[136:139], v[92:95], v[80:83]
    s_waitcnt lgkmcnt(0)
    v_mfma_f32_16x16x32_bf16 v[80:83], v[140:143], v[164:167], v[80:83]
    v_mfma_f32_16x16x32_bf16 v[80:83], v[144:147], v[176:179], v[80:83]
    v_mfma_f32_16x16x32_bf16 v[68:71], v[140:143], v[176:179], v[68:71]
    v_mfma_f32_16x16x32_bf16 v[68:71], v[136:139], v[164:167], v[68:71]
    v_mfma_f32_16x16x32_bf16 v[68:71], v[132:135], v[92:95], v[68:71]
    s_barrier
    v_mfma_f32_16x16x32_bf16 v[56:59], v[128:131], v[92:95], v[56:59]
    ds_read_b128 v[96:99], v1 offset:51200
    v_mfma_f32_16x16x32_bf16 v[56:59], v[132:135], v[164:167], v[56:59]
    ds_read_b128 v[168:171], v1 offset:57344
    v_mfma_f32_16x16x32_bf16 v[56:59], v[136:139], v[176:179], v[56:59]
    v_mfma_f32_16x16x32_bf16 v[44:47], v[132:135], v[176:179], v[44:47]
    ds_read_b128 v[180:183], v1 offset:63488
    v_mfma_f32_16x16x32_bf16 v[44:47], v[128:131], v[164:167], v[44:47]
    v_mfma_f32_16x16x32_bf16 v[44:47], v[124:127], v[92:95], v[44:47]
    v_mfma_f32_16x16x32_bf16 v[32:35], v[120:123], v[92:95], v[32:35]
    v_mfma_f32_16x16x32_bf16 v[32:35], v[124:127], v[164:167], v[32:35]
    v_mfma_f32_16x16x32_bf16 v[32:35], v[128:131], v[176:179], v[32:35]
    v_mfma_f32_16x16x32_bf16 v[20:23], v[124:127], v[176:179], v[20:23]
    v_mfma_f32_16x16x32_bf16 v[20:23], v[120:123], v[164:167], v[20:23]
    v_mfma_f32_16x16x32_bf16 v[20:23], v[116:119], v[92:95], v[20:23]
    s_waitcnt lgkmcnt(1)
    v_mfma_f32_16x16x32_bf16 v[24:27], v[116:119], v[96:99], v[24:27]
    s_waitcnt lgkmcnt(0)
    v_mfma_f32_16x16x32_bf16 v[24:27], v[120:123], v[168:171], v[24:27]
    v_mfma_f32_16x16x32_bf16 v[24:27], v[124:127], v[180:183], v[24:27]
    v_mfma_f32_16x16x32_bf16 v[36:39], v[128:131], v[180:183], v[36:39]
    v_mfma_f32_16x16x32_bf16 v[36:39], v[124:127], v[168:171], v[36:39]
    v_mfma_f32_16x16x32_bf16 v[36:39], v[120:123], v[96:99], v[36:39]
    s_barrier
    v_mfma_f32_16x16x32_bf16 v[48:51], v[124:127], v[96:99], v[48:51]
    ds_read_b128 v[88:91], v1 offset:0
    v_mfma_f32_16x16x32_bf16 v[48:51], v[128:131], v[168:171], v[48:51]
    ds_read_b128 v[100:103], v156 offset:40192
    v_mfma_f32_16x16x32_bf16 v[48:51], v[132:135], v[180:183], v[48:51]
    v_mfma_f32_16x16x32_bf16 v[60:63], v[136:139], v[180:183], v[60:63]
    ds_read_b128 v[160:163], v1 offset:6144
    v_mfma_f32_16x16x32_bf16 v[60:63], v[132:135], v[168:171], v[60:63]
    ds_read_b128 v[104:107], v152 offset:256
    v_mfma_f32_16x16x32_bf16 v[60:63], v[128:131], v[96:99], v[60:63]
    v_mfma_f32_16x16x32_bf16 v[72:75], v[132:135], v[96:99], v[72:75]
    ds_read_b128 v[108:111], v157 offset:40320
    v_mfma_f32_16x16x32_bf16 v[72:75], v[136:139], v[168:171], v[72:75]
    ds_read_b128 v[112:115], v153 offset:384
    v_mfma_f32_16x16x32_bf16 v[72:75], v[140:143], v[180:183], v[72:75]
    v_mfma_f32_16x16x32_bf16 v[84:87], v[144:147], v[180:183], v[84:87]
    ds_read_b128 v[116:119], v158 offset:40448
    v_mfma_f32_16x16x32_bf16 v[84:87], v[140:143], v[168:171], v[84:87]
    ds_read_b128 v[120:123], v154 offset:512
    v_mfma_f32_16x16x32_bf16 v[84:87], v[136:139], v[96:99], v[84:87]
    s_waitcnt lgkmcnt(4)
    v_mfma_f32_16x16x32_bf16 v[16:19], v[100:103], v[88:91], v[16:19]
    ds_read_b128 v[124:127], v159 offset:40576
    v_mfma_f32_16x16x32_bf16 v[16:19], v[104:107], v[160:163], v[16:19]
    s_waitcnt lgkmcnt(4)
    v_mfma_f32_16x16x32_bf16 v[28:31], v[104:107], v[88:91], v[28:31]
    ds_read_b128 v[164:167], v1 offset:7168
    v_mfma_f32_16x16x32_bf16 v[28:31], v[108:111], v[160:163], v[28:31]
    s_waitcnt lgkmcnt(4)
    v_mfma_f32_16x16x32_bf16 v[40:43], v[108:111], v[88:91], v[40:43]
    ds_read_b128 v[92:95], v1 offset:1024
    v_mfma_f32_16x16x32_bf16 v[40:43], v[112:115], v[160:163], v[40:43]
    s_barrier
    s_waitcnt lgkmcnt(4)
    v_mfma_f32_16x16x32_bf16 v[52:55], v[112:115], v[88:91], v[52:55]
    v_mfma_f32_16x16x32_bf16 v[52:55], v[116:119], v[160:163], v[52:55]
    s_waitcnt lgkmcnt(3)
    v_mfma_f32_16x16x32_bf16 v[64:67], v[116:119], v[88:91], v[64:67]
    v_mfma_f32_16x16x32_bf16 v[64:67], v[120:123], v[160:163], v[64:67]
    s_waitcnt lgkmcnt(2)
    v_mfma_f32_16x16x32_bf16 v[76:79], v[120:123], v[88:91], v[76:79]
    v_mfma_f32_16x16x32_bf16 v[76:79], v[124:127], v[160:163], v[76:79]
    s_waitcnt lgkmcnt(0)
    v_mfma_f32_16x16x32_bf16 v[80:83], v[124:127], v[164:167], v[80:83]
    ds_read_b128 v[96:99], v1 offset:2048
    v_mfma_f32_16x16x32_bf16 v[80:83], v[120:123], v[92:95], v[80:83]
    v_mfma_f32_16x16x32_bf16 v[68:71], v[120:123], v[164:167], v[68:71]
    ds_read_b128 v[168:171], v1 offset:8192
    v_mfma_f32_16x16x32_bf16 v[68:71], v[116:119], v[92:95], v[68:71]
    v_mfma_f32_16x16x32_bf16 v[56:59], v[116:119], v[164:167], v[56:59]
    v_mfma_f32_16x16x32_bf16 v[56:59], v[112:115], v[92:95], v[56:59]
    v_mfma_f32_16x16x32_bf16 v[44:47], v[112:115], v[164:167], v[44:47]
    v_mfma_f32_16x16x32_bf16 v[44:47], v[108:111], v[92:95], v[44:47]
    v_mfma_f32_16x16x32_bf16 v[32:35], v[108:111], v[164:167], v[32:35]
    v_mfma_f32_16x16x32_bf16 v[32:35], v[104:107], v[92:95], v[32:35]
    v_mfma_f32_16x16x32_bf16 v[20:23], v[104:107], v[164:167], v[20:23]
    v_mfma_f32_16x16x32_bf16 v[20:23], v[100:103], v[92:95], v[20:23]
    s_barrier
    s_waitcnt lgkmcnt(0)
    v_mfma_f32_16x16x32_bf16 v[24:27], v[100:103], v[96:99], v[24:27]
    ds_read_b128 v[88:91], v1 offset:12288
    v_mfma_f32_16x16x32_bf16 v[24:27], v[104:107], v[168:171], v[24:27]
    v_mfma_f32_16x16x32_bf16 v[36:39], v[104:107], v[96:99], v[36:39]
    ds_read_b128 v[160:163], v1 offset:18432
    v_mfma_f32_16x16x32_bf16 v[36:39], v[108:111], v[168:171], v[36:39]
    v_mfma_f32_16x16x32_bf16 v[48:51], v[108:111], v[96:99], v[48:51]
    v_mfma_f32_16x16x32_bf16 v[48:51], v[112:115], v[168:171], v[48:51]
    v_mfma_f32_16x16x32_bf16 v[60:63], v[112:115], v[96:99], v[60:63]
    v_mfma_f32_16x16x32_bf16 v[60:63], v[116:119], v[168:171], v[60:63]
    v_mfma_f32_16x16x32_bf16 v[72:75], v[116:119], v[96:99], v[72:75]
    ds_read_b128 v[128:131], v155 offset:640
    v_mfma_f32_16x16x32_bf16 v[72:75], v[120:123], v[168:171], v[72:75]
    v_mfma_f32_16x16x32_bf16 v[84:87], v[120:123], v[96:99], v[84:87]
    ds_read_b128 v[132:135], v152 offset:40704
    v_mfma_f32_16x16x32_bf16 v[84:87], v[124:127], v[168:171], v[84:87]
    s_waitcnt lgkmcnt(2)
    v_mfma_f32_16x16x32_bf16 v[16:19], v[108:111], v[88:91], v[16:19]
    ds_read_b128 v[164:167], v1 offset:19456
    v_mfma_f32_16x16x32_bf16 v[16:19], v[112:115], v[160:163], v[16:19]
    v_mfma_f32_16x16x32_bf16 v[28:31], v[112:115], v[88:91], v[28:31]
    ds_read_b128 v[92:95], v1 offset:13312
    v_mfma_f32_16x16x32_bf16 v[28:31], v[116:119], v[160:163], v[28:31]
    v_mfma_f32_16x16x32_bf16 v[40:43], v[116:119], v[88:91], v[40:43]
    v_mfma_f32_16x16x32_bf16 v[40:43], v[120:123], v[160:163], v[40:43]
    s_barrier
    v_mfma_f32_16x16x32_bf16 v[52:55], v[120:123], v[88:91], v[52:55]
    v_mfma_f32_16x16x32_bf16 v[52:55], v[124:127], v[160:163], v[52:55]
    s_waitcnt lgkmcnt(3)
    v_mfma_f32_16x16x32_bf16 v[64:67], v[124:127], v[88:91], v[64:67]
    v_mfma_f32_16x16x32_bf16 v[64:67], v[128:131], v[160:163], v[64:67]
    s_waitcnt lgkmcnt(2)
    v_mfma_f32_16x16x32_bf16 v[76:79], v[128:131], v[88:91], v[76:79]
    v_mfma_f32_16x16x32_bf16 v[76:79], v[132:135], v[160:163], v[76:79]
    s_waitcnt lgkmcnt(0)
    v_mfma_f32_16x16x32_bf16 v[80:83], v[132:135], v[164:167], v[80:83]
    ds_read_b128 v[96:99], v1 offset:14336
    v_mfma_f32_16x16x32_bf16 v[80:83], v[128:131], v[92:95], v[80:83]
    v_mfma_f32_16x16x32_bf16 v[68:71], v[128:131], v[164:167], v[68:71]
    ds_read_b128 v[168:171], v1 offset:20480
    v_mfma_f32_16x16x32_bf16 v[68:71], v[124:127], v[92:95], v[68:71]
    v_mfma_f32_16x16x32_bf16 v[56:59], v[124:127], v[164:167], v[56:59]
    v_mfma_f32_16x16x32_bf16 v[56:59], v[120:123], v[92:95], v[56:59]
    v_mfma_f32_16x16x32_bf16 v[44:47], v[120:123], v[164:167], v[44:47]
    v_mfma_f32_16x16x32_bf16 v[44:47], v[116:119], v[92:95], v[44:47]
    v_mfma_f32_16x16x32_bf16 v[32:35], v[116:119], v[164:167], v[32:35]
    v_mfma_f32_16x16x32_bf16 v[32:35], v[112:115], v[92:95], v[32:35]
    v_mfma_f32_16x16x32_bf16 v[20:23], v[112:115], v[164:167], v[20:23]
    v_mfma_f32_16x16x32_bf16 v[20:23], v[108:111], v[92:95], v[20:23]
    s_barrier
    s_waitcnt lgkmcnt(0)
    v_mfma_f32_16x16x32_bf16 v[24:27], v[108:111], v[96:99], v[24:27]
    ds_read_b128 v[88:91], v1 offset:24576
    v_mfma_f32_16x16x32_bf16 v[24:27], v[112:115], v[168:171], v[24:27]
    v_mfma_f32_16x16x32_bf16 v[36:39], v[112:115], v[96:99], v[36:39]
    ds_read_b128 v[160:163], v1 offset:30720
    v_mfma_f32_16x16x32_bf16 v[36:39], v[116:119], v[168:171], v[36:39]
    v_mfma_f32_16x16x32_bf16 v[48:51], v[116:119], v[96:99], v[48:51]
    v_mfma_f32_16x16x32_bf16 v[48:51], v[120:123], v[168:171], v[48:51]
    v_mfma_f32_16x16x32_bf16 v[60:63], v[120:123], v[96:99], v[60:63]
    v_mfma_f32_16x16x32_bf16 v[60:63], v[124:127], v[168:171], v[60:63]
    v_mfma_f32_16x16x32_bf16 v[72:75], v[124:127], v[96:99], v[72:75]
    ds_read_b128 v[136:139], v156 offset:768
    v_mfma_f32_16x16x32_bf16 v[72:75], v[128:131], v[168:171], v[72:75]
    v_mfma_f32_16x16x32_bf16 v[84:87], v[128:131], v[96:99], v[84:87]
    ds_read_b128 v[140:143], v153 offset:40832
    v_mfma_f32_16x16x32_bf16 v[84:87], v[132:135], v[168:171], v[84:87]
    s_waitcnt lgkmcnt(2)
    v_mfma_f32_16x16x32_bf16 v[16:19], v[116:119], v[88:91], v[16:19]
L_pad_m3:
    s_cbranch_scc1 L_ret
    ds_read_b128 v[164:167], v1 offset:31744
    v_mfma_f32_16x16x32_bf16 v[16:19], v[120:123], v[160:163], v[16:19]
    v_mfma_f32_16x16x32_bf16 v[28:31], v[120:123], v[88:91], v[28:31]
    ds_read_b128 v[92:95], v1 offset:25600
    v_mfma_f32_16x16x32_bf16 v[28:31], v[124:127], v[160:163], v[28:31]
    v_mfma_f32_16x16x32_bf16 v[40:43], v[124:127], v[88:91], v[40:43]
    v_mfma_f32_16x16x32_bf16 v[40:43], v[128:131], v[160:163], v[40:43]
    s_barrier
    v_mfma_f32_16x16x32_bf16 v[52:55], v[128:131], v[88:91], v[52:55]
    v_mfma_f32_16x16x32_bf16 v[52:55], v[132:135], v[160:163], v[52:55]
    s_waitcnt lgkmcnt(3)
    v_mfma_f32_16x16x32_bf16 v[64:67], v[132:135], v[88:91], v[64:67]
    v_mfma_f32_16x16x32_bf16 v[64:67], v[136:139], v[160:163], v[64:67]
    s_waitcnt lgkmcnt(2)
    v_mfma_f32_16x16x32_bf16 v[76:79], v[136:139], v[88:91], v[76:79]
    v_mfma_f32_16x16x32_bf16 v[76:79], v[140:143], v[160:163], v[76:79]
    s_waitcnt lgkmcnt(0)
    v_mfma_f32_16x16x32_bf16 v[80:83], v[140:143], v[164:167], v[80:83]
    ds_read_b128 v[96:99], v1 offset:26624
    v_mfma_f32_16x16x32_bf16 v[80:83], v[136:139], v[92:95], v[80:83]
    v_mfma_f32_16x16x32_bf16 v[68:71], v[136:139], v[164:167], v[68:71]
    ds_read_b128 v[168:171], v1 offset:32768
    v_mfma_f32_16x16x32_bf16 v[68:71], v[132:135], v[92:95], v[68:71]
    v_mfma_f32_16x16x32_bf16 v[56:59], v[132:135], v[164:167], v[56:59]
    v_mfma_f32_16x16x32_bf16 v[56:59], v[128:131], v[92:95], v[56:59]
    v_mfma_f32_16x16x32_bf16 v[44:47], v[128:131], v[164:167], v[44:47]
    v_mfma_f32_16x16x32_bf16 v[44:47], v[124:127], v[92:95], v[44:47]
    v_mfma_f32_16x16x32_bf16 v[32:35], v[124:127], v[164:167], v[32:35]
    v_mfma_f32_16x16x32_bf16 v[32:35], v[120:123], v[92:95], v[32:35]
    v_mfma_f32_16x16x32_bf16 v[20:23], v[120:123], v[164:167], v[20:23]
    v_mfma_f32_16x16x32_bf16 v[20:23], v[116:119], v[92:95], v[20:23]
    s_barrier
    s_waitcnt lgkmcnt(0)
    v_mfma_f32_16x16x32_bf16 v[24:27], v[116:119], v[96:99], v[24:27]
    ds_read_b128 v[88:91], v1 offset:36864
    v_mfma_f32_16x16x32_bf16 v[24:27], v[120:123], v[168:171], v[24:27]
    v_mfma_f32_16x16x32_bf16 v[36:39], v[120:123], v[96:99], v[36:39]
    ds_read_b128 v[160:163], v1 offset:43008
    v_mfma_f32_16x16x32_bf16 v[36:39], v[124:127], v[168:171], v[36:39]
    v_mfma_f32_16x16x32_bf16 v[48:51], v[124:127], v[96:99], v[48:51]
    v_mfma_f32_16x16x32_bf16 v[48:51], v[128:131], v[168:171], v[48:51]
    v_mfma_f32_16x16x32_bf16 v[60:63], v[128:131], v[96:99], v[60:63]
    v_mfma_f32_16x16x32_bf16 v[60:63], v[132:135], v[168:171], v[60:63]
    v_mfma_f32_16x16x32_bf16 v[72:75], v[132:135], v[96:99], v[72:75]
    ds_read_b128 v[144:147], v157 offset:896
    v_mfma_f32_16x16x32_bf16 v[72:75], v[136:139], v[168:171], v[72:75]
    v_mfma_f32_16x16x32_bf16 v[84:87], v[136:139], v[96:99], v[84:87]
    ds_read_b128 v[148:151], v154 offset:40960
    v_mfma_f32_16x16x32_bf16 v[84:87], v[140:143], v[168:171], v[84:87]
    s_waitcnt lgkmcnt(2)
    v_mfma_f32_16x16x32_bf16 v[16:19], v[124:127], v[88:91], v[16:19]
    ds_read_b128 v[164:167], v1 offset:44032
    v_mfma_f32_16x16x32_bf16 v[16:19], v[128:131], v[160:163], v[16:19]
    v_mfma_f32_16x16x32_bf16 v[28:31], v[128:131], v[88:91], v[28:31]
    ds_read_b128 v[92:95], v1 offset:37888
    v_mfma_f32_16x16x32_bf16 v[28:31], v[132:135], v[160:163], v[28:31]
    v_mfma_f32_16x16x32_bf16 v[40:43], v[132:135], v[88:91], v[40:43]
    v_mfma_f32_16x16x32_bf16 v[40:43], v[136:139], v[160:163], v[40:43]
    s_barrier
    v_mfma_f32_16x16x32_bf16 v[52:55], v[136:139], v[88:91], v[52:55]
    v_mfma_f32_16x16x32_bf16 v[52:55], v[140:143], v[160:163], v[52:55]
    s_waitcnt lgkmcnt(3)
    v_mfma_f32_16x16x32_bf16 v[64:67], v[140:143], v[88:91], v[64:67]
    v_mfma_f32_16x16x32_bf16 v[64:67], v[144:147], v[160:163], v[64:67]
    s_waitcnt lgkmcnt(2)
    v_mfma_f32_16x16x32_bf16 v[76:79], v[144:147], v[88:91], v[76:79]
    v_mfma_f32_16x16x32_bf16 v[76:79], v[148:151], v[160:163], v[76:79]
    s_waitcnt lgkmcnt(0)
    v_mfma_f32_16x16x32_bf16 v[80:83], v[148:151], v[164:167], v[80:83]
    ds_read_b128 v[96:99], v1 offset:38912
    v_mfma_f32_16x16x32_bf16 v[80:83], v[144:147], v[92:95], v[80:83]
    v_mfma_f32_16x16x32_bf16 v[68:71], v[144:147], v[164:167], v[68:71]
    ds_read_b128 v[168:171], v1 offset:45056
    v_mfma_f32_16x16x32_bf16 v[68:71], v[140:143], v[92:95], v[68:71]
    v_mfma_f32_16x16x32_bf16 v[56:59], v[140:143], v[164:167], v[56:59]
    v_mfma_f32_16x16x32_bf16 v[56:59], v[136:139], v[92:95], v[56:59]
    v_mfma_f32_16x16x32_bf16 v[44:47], v[136:139], v[164:167], v[44:47]
    v_mfma_f32_16x16x32_bf16 v[44:47], v[132:135], v[92:95], v[44:47]
    v_mfma_f32_16x16x32_bf16 v[32:35], v[132:135], v[164:167], v[32:35]
    v_mfma_f32_16x16x32_bf16 v[32:35], v[128:131], v[92:95], v[32:35]
    v_mfma_f32_16x16x32_bf16 v[20:23], v[128:131], v[164:167], v[20:23]
    v_mfma_f32_16x16x32_bf16 v[20:23], v[124:127], v[92:95], v[20:23]
    s_barrier
    s_waitcnt lgkmcnt(0)
    v_mfma_f32_16x16x32_bf16 v[24:27], v[124:127], v[96:99], v[24:27]
    ds_read_b128 v[88:91], v1 offset:49152
    v_mfma_f32_16x16x32_bf16 v[24:27], v[128:131], v[168:171], v[24:27]
    v_mfma_f32_16x16x32_bf16 v[36:39], v[128:131], v[96:99], v[36:39]
    ds_read_b128 v[100:103], v152 offset:13568
    v_mfma_f32_16x16x32_bf16 v[36:39], v[132:135], v[168:171], v[36:39]
    v_mfma_f32_16x16x32_bf16 v[48:51], v[132:135], v[96:99], v[48:51]
    ds_read_b128 v[160:163], v1 offset:55296
    v_mfma_f32_16x16x32_bf16 v[48:51], v[136:139], v[168:171], v[48:51]
    v_mfma_f32_16x16x32_bf16 v[60:63], v[136:139], v[96:99], v[60:63]
    ds_read_b128 v[104:107], v156 offset:256
    v_mfma_f32_16x16x32_bf16 v[60:63], v[140:143], v[168:171], v[60:63]
    v_mfma_f32_16x16x32_bf16 v[72:75], v[140:143], v[96:99], v[72:75]
    ds_read_b128 v[108:111], v153 offset:13696
    v_mfma_f32_16x16x32_bf16 v[72:75], v[144:147], v[168:171], v[72:75]
    v_mfma_f32_16x16x32_bf16 v[84:87], v[144:147], v[96:99], v[84:87]
    ds_read_b128 v[112:115], v157 offset:384
    v_mfma_f32_16x16x32_bf16 v[84:87], v[148:151], v[168:171], v[84:87]
    s_waitcnt lgkmcnt(2)
    v_mfma_f32_16x16x32_bf16 v[16:19], v[100:103], v[88:91], v[16:19]
    ds_read_b128 v[116:119], v154 offset:13824
    v_mfma_f32_16x16x32_bf16 v[16:19], v[104:107], v[160:163], v[16:19]
    s_waitcnt lgkmcnt(2)
    v_mfma_f32_16x16x32_bf16 v[28:31], v[104:107], v[88:91], v[28:31]
    ds_read_b128 v[120:123], v158 offset:512
    v_mfma_f32_16x16x32_bf16 v[28:31], v[108:111], v[160:163], v[28:31]
    s_waitcnt lgkmcnt(2)
    v_mfma_f32_16x16x32_bf16 v[40:43], v[108:111], v[88:91], v[40:43]
    ds_read_b128 v[124:127], v155 offset:13952
    v_mfma_f32_16x16x32_bf16 v[40:43], v[112:115], v[160:163], v[40:43]
    s_barrier
    ds_read_b128 v[164:167], v1 offset:56320
    s_waitcnt lgkmcnt(3)
    v_mfma_f32_16x16x32_bf16 v[52:55], v[112:115], v[88:91], v[52:55]
    ds_read_b128 v[92:95], v1 offset:50176
    v_mfma_f32_16x16x32_bf16 v[52:55], v[116:119], v[160:163], v[52:55]
    s_waitcnt lgkmcnt(3)
    v_mfma_f32_16x16x32_bf16 v[64:67], v[116:119], v[88:91], v[64:67]
    v_mfma_f32_16x16x32_bf16 v[64:67], v[120:123], v[160:163], v[64:67]
    s_waitcnt lgkmcnt(2)
    v_mfma_f32_16x16x32_bf16 v[76:79], v[120:123], v[88:91], v[76:79]
    v_mfma_f32_16x16x32_bf16 v[76:79], v[124:127], v[160:163], v[76:79]
    s_waitcnt lgkmcnt(0)
    v_mfma_f32_16x16x32_bf16 v[80:83], v[124:127], v[164:167], v[80:83]
    ds_read_b128 v[96:99], v1 offset:51200
    v_mfma_f32_16x16x32_bf16 v[80:83], v[120:123], v[92:95], v[80:83]
    v_mfma_f32_16x16x32_bf16 v[68:71], v[120:123], v[164:167], v[68:71]
    ds_read_b128 v[168:171], v1 offset:57344
    v_mfma_f32_16x16x32_bf16 v[68:71], v[116:119], v[92:95], v[68:71]
    v_mfma_f32_16x16x32_bf16 v[56:59], v[116:119], v[164:167], v[56:59]
    v_mfma_f32_16x16x32_bf16 v[56:59], v[112:115], v[92:95], v[56:59]
    v_mfma_f32_16x16x32_bf16 v[44:47], v[112:115], v[164:167], v[44:47]
    v_mfma_f32_16x16x32_bf16 v[44:47], v[108:111], v[92:95], v[44:47]
    v_mfma_f32_16x16x32_bf16 v[32:35], v[108:111], v[164:167], v[32:35]
    v_mfma_f32_16x16x32_bf16 v[32:35], v[104:107], v[92:95], v[32:35]
    v_mfma_f32_16x16x32_bf16 v[20:23], v[104:107], v[164:167], v[20:23]
    v_mfma_f32_16x16x32_bf16 v[20:23], v[100:103], v[92:95], v[20:23]
    s_barrier
    ds_read_b128 v[88:91], v1 offset:61440
    s_waitcnt lgkmcnt(1)
    v_mfma_f32_16x16x32_bf16 v[24:27], v[100:103], v[96:99], v[24:27]
    ds_read_b128 v[160:163], v1 offset:0
    v_mfma_f32_16x16x32_bf16 v[24:27], v[104:107], v[168:171], v[24:27]
    ds_read_b128 v[172:175], v1 offset:6144
    v_mfma_f32_16x16x32_bf16 v[36:39], v[104:107], v[96:99], v[36:39]
    ds_read_b128 v[128:131], v159 offset:640
    v_mfma_f32_16x16x32_bf16 v[36:39], v[108:111], v[168:171], v[36:39]
    ds_read_b128 v[184:187], v1 offset:12288
    v_mfma_f32_16x16x32_bf16 v[48:51], v[108:111], v[96:99], v[48:51]
    ds_read_b128 v[132:135], v156 offset:14080
    v_mfma_f32_16x16x32_bf16 v[48:51], v[112:115], v[168:171], v[48:51]
    ds_read_b128 v[196:199], v1 offset:18432
    v_mfma_f32_16x16x32_bf16 v[60:63], v[112:115], v[96:99], v[60:63]
    ds_read_b128 v[136:139], v152 offset:768
    v_mfma_f32_16x16x32_bf16 v[60:63], v[116:119], v[168:171], v[60:63]
    ds_read_b128 v[140:143], v157 offset:14208
    v_mfma_f32_16x16x32_bf16 v[72:75], v[116:119], v[96:99], v[72:75]
    v_mfma_f32_16x16x32_bf16 v[72:75], v[120:123], v[168:171], v[72:75]
    v_mfma_f32_16x16x32_bf16 v[84:87], v[120:123], v[96:99], v[84:87]
    v_mfma_f32_16x16x32_bf16 v[84:87], v[124:127], v[168:171], v[84:87]
    s_waitcnt lgkmcnt(7)
    v_mfma_f32_16x16x32_bf16 v[52:55], v[120:123], v[88:91], v[52:55]
    s_waitcnt lgkmcnt(5)
    v_mfma_f32_16x16x32_bf16 v[52:55], v[124:127], v[160:163], v[52:55]
    ds_read_b128 v[144:147], v153 offset:896
    s_waitcnt lgkmcnt(4)
    v_mfma_f32_16x16x32_bf16 v[52:55], v[128:131], v[172:175], v[52:55]
    ds_read_b128 v[92:95], v1 offset:62464
    s_waitcnt lgkmcnt(3)
    v_mfma_f32_16x16x32_bf16 v[52:55], v[132:135], v[184:187], v[52:55]
    ds_read_b128 v[164:167], v1 offset:1024
    v_mfma_f32_16x16x32_bf16 v[52:55], v[136:139], v[196:199], v[52:55]
    ds_read_b128 v[176:179], v1 offset:7168
    s_waitcnt lgkmcnt(4)
    v_mfma_f32_16x16x32_bf16 v[64:67], v[140:143], v[196:199], v[64:67]
    ds_read_b128 v[188:191], v1 offset:13312
    v_mfma_f32_16x16x32_bf16 v[64:67], v[136:139], v[184:187], v[64:67]
    ds_read_b128 v[200:203], v1 offset:19456
    v_mfma_f32_16x16x32_bf16 v[64:67], v[132:135], v[172:175], v[64:67]
    v_mfma_f32_16x16x32_bf16 v[64:67], v[128:131], v[160:163], v[64:67]
    v_mfma_f32_16x16x32_bf16 v[64:67], v[124:127], v[88:91], v[64:67]
    v_mfma_f32_16x16x32_bf16 v[76:79], v[128:131], v[88:91], v[76:79]
    ds_write_b128 v5, v[52:55] offset:0
    v_mfma_f32_16x16x32_bf16 v[76:79], v[132:135], v[160:163], v[76:79]
    v_mfma_f32_16x16x32_bf16 v[76:79], v[136:139], v[172:175], v[76:79]
    s_waitcnt lgkmcnt(6)
    v_mfma_f32_16x16x32_bf16 v[76:79], v[140:143], v[184:187], v[76:79]
    v_mfma_f32_16x16x32_bf16 v[76:79], v[144:147], v[196:199], v[76:79]
    s_waitcnt lgkmcnt(4)
    v_mfma_f32_16x16x32_bf16 v[56:59], v[120:123], v[92:95], v[56:59]
    ds_write_b128 v5, v[64:67] offset:1024
    s_waitcnt lgkmcnt(4)
    v_mfma_f32_16x16x32_bf16 v[56:59], v[124:127], v[164:167], v[56:59]
    s_waitcnt lgkmcnt(3)
    v_mfma_f32_16x16x32_bf16 v[56:59], v[128:131], v[176:179], v[56:59]
    ds_read_b128 v[96:99], v1 offset:63488
    s_waitcnt lgkmcnt(3)
    v_mfma_f32_16x16x32_bf16 v[56:59], v[132:135], v[188:191], v[56:59]
    ds_read_b128 v[168:171], v1 offset:2048
    v_mfma_f32_16x16x32_bf16 v[56:59], v[136:139], v[200:203], v[56:59]
    ds_read_b128 v[180:183], v1 offset:8192
    v_mfma_f32_16x16x32_bf16 v[68:71], v[140:143], v[200:203], v[68:71]
    ds_write_b128 v5, v[76:79] offset:2048
    v_mfma_f32_16x16x32_bf16 v[68:71], v[136:139], v[188:191], v[68:71]
    ds_read_b128 v[192:195], v1 offset:14336
    v_mfma_f32_16x16x32_bf16 v[68:71], v[132:135], v[176:179], v[68:71]
    ds_read_b128 v[204:207], v1 offset:20480
    v_mfma_f32_16x16x32_bf16 v[68:71], v[128:131], v[164:167], v[68:71]
    v_mfma_f32_16x16x32_bf16 v[68:71], v[124:127], v[92:95], v[68:71]
    v_mfma_f32_16x16x32_bf16 v[80:83], v[128:131], v[92:95], v[80:83]
    ds_write_b128 v5, v[56:59] offset:3072
    v_mfma_f32_16x16x32_bf16 v[80:83], v[132:135], v[164:167], v[80:83]
    v_mfma_f32_16x16x32_bf16 v[80:83], v[136:139], v[176:179], v[80:83]
    v_mfma_f32_16x16x32_bf16 v[80:83], v[140:143], v[188:191], v[80:83]
    v_mfma_f32_16x16x32_bf16 v[80:83], v[144:147], v[200:203], v[80:83]
    s_waitcnt lgkmcnt(5)
    v_mfma_f32_16x16x32_bf16 v[60:63], v[120:123], v[96:99], v[60:63]
    ds_write_b128 v5, v[68:71] offset:4096
    s_waitcnt lgkmcnt(5)
    v_mfma_f32_16x16x32_bf16 v[60:63], v[124:127], v[168:171], v[60:63]
    s_waitcnt lgkmcnt(3)
    v_mfma_f32_16x16x32_bf16 v[60:63], v[128:131], v[180:183], v[60:63]
    s_waitcnt lgkmcnt(2)
    v_mfma_f32_16x16x32_bf16 v[60:63], v[132:135], v[192:195], v[60:63]
    v_mfma_f32_16x16x32_bf16 v[60:63], v[136:139], v[204:207], v[60:63]
    v_mfma_f32_16x16x32_bf16 v[72:75], v[140:143], v[204:207], v[72:75]
    ds_write_b128 v5, v[80:83] offset:5120
    v_mfma_f32_16x16x32_bf16 v[72:75], v[136:139], v[192:195], v[72:75]
    v_mfma_f32_16x16x32_bf16 v[72:75], v[132:135], v[180:183], v[72:75]
    v_mfma_f32_16x16x32_bf16 v[72:75], v[128:131], v[168:171], v[72:75]
    v_mfma_f32_16x16x32_bf16 v[72:75], v[124:127], v[96:99], v[72:75]
    s_waitcnt lgkmcnt(1)
    s_barrier
    ds_read_b128 v[52:55], v5 offset:18432
    v_mfma_f32_16x16x32_bf16 v[84:87], v[128:131], v[96:99], v[84:87]
    ds_write_b128 v5, v[60:63] offset:6144
    v_mfma_f32_16x16x32_bf16 v[84:87], v[132:135], v[168:171], v[84:87]
    ds_read_b128 v[64:67], v5 offset:19456
    v_mfma_f32_16x16x32_bf16 v[84:87], v[136:139], v[180:183], v[84:87]
    ds_read_b128 v[76:79], v5 offset:20480
    v_mfma_f32_16x16x32_bf16 v[84:87], v[140:143], v[192:195], v[84:87]
    ds_read_b128 v[56:59], v5 offset:21504
    v_mfma_f32_16x16x32_bf16 v[84:87], v[144:147], v[204:207], v[84:87]
    ds_read_b128 v[68:71], v5 offset:22528
    v_mfma_f32_16x16x32_bf16 v[16:19], v[108:111], v[88:91], v[16:19]
    ds_write_b128 v5, v[72:75] offset:7168
    v_mfma_f32_16x16x32_bf16 v[16:19], v[112:115], v[160:163], v[16:19]
    v_mfma_f32_16x16x32_bf16 v[16:19], v[116:119], v[172:175], v[16:19]
    s_waitcnt lgkmcnt(4)
    v_add_f32 v28, v28, v64
    v_add_f32 v29, v29, v65
    v_mfma_f32_16x16x32_bf16 v[16:19], v[120:123], v[184:187], v[16:19]
    v_add_f32 v30, v30, v66
    v_add_f32 v31, v31, v67
    v_mfma_f32_16x16x32_bf16 v[16:19], v[124:127], v[196:199], v[16:19]
    s_waitcnt lgkmcnt(3)
    v_add_f32 v40, v40, v76
    v_add_f32 v41, v41, v77
    v_mfma_f32_16x16x32_bf16 v[28:31], v[128:131], v[196:199], v[28:31]
    ds_write_b128 v5, v[84:87] offset:8192
    v_add_f32 v42, v42, v78
    v_mfma_f32_16x16x32_bf16 v[28:31], v[124:127], v[184:187], v[28:31]
    v_add_f32 v43, v43, v79
    s_waitcnt lgkmcnt(3)
    v_add_f32 v20, v20, v56
    v_mfma_f32_16x16x32_bf16 v[28:31], v[120:123], v[172:175], v[28:31]
    v_add_f32 v21, v21, v57
    v_add_f32 v22, v22, v58
    v_mfma_f32_16x16x32_bf16 v[28:31], v[116:119], v[160:163], v[28:31]
    v_add_f32 v23, v23, v59
    s_waitcnt lgkmcnt(2)
    v_add_f32 v32, v32, v68
    v_mfma_f32_16x16x32_bf16 v[28:31], v[112:115], v[88:91], v[28:31]
    v_add_f32 v33, v33, v69
    v_add_f32 v34, v34, v70
    v_mfma_f32_16x16x32_bf16 v[40:43], v[116:119], v[88:91], v[40:43]
    v_add_f32 v35, v35, v71
    v_add_f32 v16, v16, v52
    v_mfma_f32_16x16x32_bf16 v[40:43], v[120:123], v[160:163], v[40:43]
    v_add_f32 v17, v17, v53
    v_add_f32 v18, v18, v54
    v_mfma_f32_16x16x32_bf16 v[40:43], v[124:127], v[172:175], v[40:43]
    v_add_f32 v19, v19, v55
    v_add_f32 v232, v16, v17
    v_mfma_f32_16x16x32_bf16 v[40:43], v[128:131], v[184:187], v[40:43]
    v_mul_f32 v233, v16, v16
    v_fmac_f32 v233, v17, v17
    v_mfma_f32_16x16x32_bf16 v[40:43], v[132:135], v[196:199], v[40:43]
    s_waitcnt lgkmcnt(0)
    s_barrier
    ds_read_b128 v[80:83], v5 offset:23552
    v_add_f32 v232, v232, v18
    v_mfma_f32_16x16x32_bf16 v[20:23], v[108:111], v[92:95], v[20:23]
    ds_read_b128 v[60:63], v5 offset:24576
    v_fmac_f32 v233, v18, v18
    v_mfma_f32_16x16x32_bf16 v[20:23], v[112:115], v[164:167], v[20:23]
    ds_read_b128 v[72:75], v5 offset:25600
    v_add_f32 v232, v232, v19
    v_mfma_f32_16x16x32_bf16 v[20:23], v[116:119], v[176:179], v[20:23]
    ds_read_b128 v[84:87], v5 offset:26624
    v_fmac_f32 v233, v19, v19
    v_mfma_f32_16x16x32_bf16 v[20:23], v[120:123], v[188:191], v[20:23]
    v_add_f32 v232, v232, v28
    v_fmac_f32 v233, v28, v28
    v_mfma_f32_16x16x32_bf16 v[20:23], v[124:127], v[200:203], v[20:23]
    v_add_f32 v232, v232, v29
    v_fmac_f32 v233, v29, v29
    v_mfma_f32_16x16x32_bf16 v[32:35], v[128:131], v[200:203], v[32:35]
    s_waitcnt lgkmcnt(3)
    v_add_f32 v44, v44, v80
    v_add_f32 v45, v45, v81
    v_mfma_f32_16x16x32_bf16 v[32:35], v[124:127], v[188:191], v[32:35]
    v_add_f32 v46, v46, v82
    v_add_f32 v47, v47, v83
    v_mfma_f32_16x16x32_bf16 v[32:35], v[120:123], v[176:179], v[32:35]
    s_waitcnt lgkmcnt(2)
    v_add_f32 v24, v24, v60
    v_add_f32 v25, v25, v61
    v_mfma_f32_16x16x32_bf16 v[32:35], v[116:119], v[164:167], v[32:35]
    v_add_f32 v26, v26, v62
    v_add_f32 v27, v27, v63
    v_mfma_f32_16x16x32_bf16 v[32:35], v[112:115], v[92:95], v[32:35]
    s_waitcnt lgkmcnt(1)
    v_add_f32 v36, v36, v72
    v_add_f32 v37, v37, v73
    v_mfma_f32_16x16x32_bf16 v[44:47], v[116:119], v[92:95], v[44:47]
    v_add_f32 v38, v38, v74
    v_add_f32 v39, v39, v75
    v_mfma_f32_16x16x32_bf16 v[44:47], v[120:123], v[164:167], v[44:47]
    s_waitcnt lgkmcnt(0)
    v_add_f32 v48, v48, v84
    v_add_f32 v49, v49, v85
    v_mfma_f32_16x16x32_bf16 v[44:47], v[124:127], v[176:179], v[44:47]
    v_add_f32 v50, v50, v86
    v_add_f32 v51, v51, v87
    v_mfma_f32_16x16x32_bf16 v[44:47], v[128:131], v[188:191], v[44:47]
    v_add_f32 v232, v232, v30
    v_fmac_f32 v233, v30, v30
    v_mfma_f32_16x16x32_bf16 v[44:47], v[132:135], v[200:203], v[44:47]
    v_add_f32 v232, v232, v31
    v_fmac_f32 v233, v31, v31
    v_mfma_f32_16x16x32_bf16 v[24:27], v[108:111], v[96:99], v[24:27]
    v_cndmask_b32 v42, 0, v42, s[54:55]
    v_add_f32 v232, v232, v40
    v_mfma_f32_16x16x32_bf16 v[24:27], v[112:115], v[168:171], v[24:27]
    v_fmac_f32 v233, v40, v40
    v_add_f32 v232, v232, v41
    v_mfma_f32_16x16x32_bf16 v[24:27], v[116:119], v[180:183], v[24:27]
    v_fmac_f32 v233, v41, v41
    v_add_f32 v232, v232, v42
    v_mfma_f32_16x16x32_bf16 v[24:27], v[120:123], v[192:195], v[24:27]
    v_fmac_f32 v233, v42, v42
    v_add_f32 v232, v232, v43
    v_mfma_f32_16x16x32_bf16 v[24:27], v[124:127], v[204:207], v[24:27]
    s_barrier
    v_fmac_f32 v233, v43, v43
    v_add_f32 v234, v20, v21
    v_mfma_f32_16x16x32_bf16 v[36:39], v[128:131], v[204:207], v[36:39]
    v_mul_f32 v235, v20, v20
    v_fmac_f32 v235, v21, v21
    v_mfma_f32_16x16x32_bf16 v[36:39], v[124:127], v[192:195], v[36:39]
    v_add_f32 v234, v234, v22
    v_fmac_f32 v235, v22, v22
    v_mfma_f32_16x16x32_bf16 v[36:39], v[120:123], v[180:183], v[36:39]
    v_add_f32 v234, v234, v23
    v_fmac_f32 v235, v23, v23
    v_mfma_f32_16x16x32_bf16 v[36:39], v[116:119], v[168:171], v[36:39]
    v_add_f32 v234, v234, v32
    v_fmac_f32 v235, v32, v32
    v_mfma_f32_16x16x32_bf16 v[36:39], v[112:115], v[96:99], v[36:39]
    v_add_f32 v234, v234, v33
    v_fmac_f32 v235, v33, v33
    v_mfma_f32_16x16x32_bf16 v[48:51], v[116:119], v[96:99], v[48:51]
    v_add_f32 v234, v234, v34
    v_fmac_f32 v235, v34, v34
    v_mfma_f32_16x16x32_bf16 v[48:51], v[120:123], v[168:171], v[48:51]
    v_add_f32 v234, v234, v35
    v_fmac_f32 v235, v35, v35
    v_mfma_f32_16x16x32_bf16 v[48:51], v[124:127], v[180:183], v[48:51]
    v_cndmask_b32 v46, 0, v46, s[54:55]
    v_add_f32 v234, v234, v44
    v_mfma_f32_16x16x32_bf16 v[48:51], v[128:131], v[192:195], v[48:51]
    v_fmac_f32 v235, v44, v44
    v_add_f32 v234, v234, v45
    v_mfma_f32_16x16x32_bf16 v[48:51], v[132:135], v[204:207], v[48:51]
    v_fmac_f32 v235, v45, v45
    v_add_f32 v234, v234, v46
    v_fmac_f32 v235, v46, v46
    v_add_f32 v234, v234, v47
    v_fmac_f32 v235, v47, v47
    v_add_f32 v236, v24, v25
    v_mul_f32 v237, v24, v24
    v_fmac_f32 v237, v25, v25
    v_add_f32 v236, v236, v26
    v_fmac_f32 v237, v26, v26
    v_add_f32 v236, v236, v27
    v_fmac_f32 v237, v27, v27
    v_add_f32 v236, v236, v36
    v_fmac_f32 v237, v36, v36
    v_add_f32 v236, v236, v37
    v_fmac_f32 v237, v37, v37
    v_add_f32 v236, v236, v38
    v_fmac_f32 v237, v38, v38
    v_add_f32 v236, v236, v39
    v_fmac_f32 v237, v39, v39
    v_cndmask_b32 v50, 0, v50, s[54:55]
    v_add_f32 v236, v236, v48
    v_fmac_f32 v237, v48, v48
    v_add_f32 v236, v236, v49
    v_fmac_f32 v237, v49, v49
    v_add_f32 v236, v236, v50
    v_fmac_f32 v237, v50, v50
    v_add_f32 v236, v236, v51
    v_fmac_f32 v237, v51, v51
    v_permlane32_swap_b32 v232, v233
    v_permlane32_swap_b32 v234, v235
    v_permlane32_swap_b32 v236, v237
    v_add_f32 v232, v232, v233
    v_add_f32 v234, v234, v235
    v_add_f32 v236, v236, v237
    v_mov_b32 v237, v236
    v_permlane16_swap_b32 v232, v234
    v_add_f32 v232, v232, v234
    v_permlane16_swap_b32 v236, v237
    v_add_f32 v236, v236, v237
    ds_write2_b32 v7, v232, v236 offset1:64
    s_setprio 0
    s_waitcnt lgkmcnt(0)
    s_barrier
    v_add_u32 v10, 1152, v6
    v_add_u32 v11, 2304, v6
    v_add_u32 v12, 3456, v6
    s_barrier
    ds_write2_b32 v6, v16, v20 offset0:0 offset1:16
    ds_write2_b32 v6, v24, v28 offset0:32 offset1:48
    ds_write2_b32 v6, v32, v36 offset0:64 offset1:80
    ds_write2_b32 v6, v40, v44 offset0:96 offset1:112
    ds_write_b32 v6, v48 offset:512
    ds_write2_b32 v10, v17, v21 offset0:0 offset1:16
    ds_write2_b32 v10, v25, v29 offset0:32 offset1:48
    ds_write2_b32 v10, v33, v37 offset0:64 offset1:80
    ds_write2_b32 v10, v41, v45 offset0:96 offset1:112
    ds_write_b32 v10, v49 offset:512
    ds_write2_b32 v11, v18, v22 offset0:0 offset1:16
    ds_write2_b32 v11, v26, v30 offset0:32 offset1:48
    ds_write2_b32 v11, v34, v38 offset0:64 offset1:80
    ds_write2_b32 v11, v42, v46 offset0:96 offset1:112
    ds_write_b32 v11, v50 offset:512
    ds_write2_b32 v12, v19, v23 offset0:0 offset1:16
    ds_write2_b32 v12, v27, v31 offset0:32 offset1:48
    ds_write2_b32 v12, v35, v39 offset0:64 offset1:80
    ds_write2_b32 v12, v43, v47 offset0:96 offset1:112
    ds_write_b32 v12, v51 offset:512
    s_waitcnt lgkmcnt(0)
    s_barrier
    ds_read_b64 v[100:101], v4 offset:0
    ds_read_b64 v[102:103], v4 offset:8
    ds_read_b64 v[104:105], v4 offset:16
    ds_read_b64 v[106:107], v4 offset:1536
    ds_read_b64 v[108:109], v4 offset:1544
    ds_read_b64 v[110:111], v4 offset:1552
    ds_read_b64 v[112:113], v4 offset:3072
    ds_read_b64 v[114:115], v4 offset:3080
    ds_read_b64 v[116:117], v4 offset:3088
    s_branch L_final
L_pad_k1:
    s_branch L_ret
L_s_k1:
    ds_read_b128 v[172:175], v1 offset:12288
    v_mfma_f32_16x16x32_bf16 v[48:51], v[120:123], v[168:171], v[48:51]
    v_mfma_f32_16x16x32_bf16 v[60:63], v[120:123], v[96:99], v[60:63]
    v_mfma_f32_16x16x32_bf16 v[60:63], v[124:127], v[168:171], v[60:63]
    v_mfma_f32_16x16x32_bf16 v[72:75], v[124:127], v[96:99], v[72:75]
    ds_read_b128 v[136:139], v156 offset:27392
    v_mfma_f32_16x16x32_bf16 v[72:75], v[128:131], v[168:171], v[72:75]
    v_mfma_f32_16x16x32_bf16 v[84:87], v[128:131], v[96:99], v[84:87]
    v_mfma_f32_16x16x32_bf16 v[84:87], v[132:135], v[168:171], v[84:87]
    s_waitcnt lgkmcnt(2)
    v_mfma_f32_16x16x32_bf16 v[16:19], v[116:119], v[88:91], v[16:19]
    s_waitcnt lgkmcnt(1)
    v_mfma_f32_16x16x32_bf16 v[16:19], v[120:123], v[160:163], v[16:19]
    ds_read_b128 v[140:143], v153 offset:14208
    v_mfma_f32_16x16x32_bf16 v[16:19], v[124:127], v[172:175], v[16:19]
    v_mfma_f32_16x16x32_bf16 v[28:31], v[128:131], v[172:175], v[28:31]
    ds_read_b128 v[144:147], v157 offset:27520
    v_mfma_f32_16x16x32_bf16 v[28:31], v[124:127], v[160:163], v[28:31]
    v_mfma_f32_16x16x32_bf16 v[28:31], v[120:123], v[88:91], v[28:31]
    s_barrier
    v_mfma_f32_16x16x32_bf16 v[40:43], v[124:127], v[88:91], v[40:43]
    ds_read_b128 v[92:95], v1 offset:1024
    v_mfma_f32_16x16x32_bf16 v[40:43], v[128:131], v[160:163], v[40:43]
    ds_read_b128 v[164:167], v1 offset:7168
    v_mfma_f32_16x16x32_bf16 v[40:43], v[132:135], v[172:175], v[40:43]
    s_waitcnt lgkmcnt(4)
    v_mfma_f32_16x16x32_bf16 v[52:55], v[136:139], v[172:175], v[52:55]
    ds_read_b128 v[176:179], v1 offset:13312
    v_mfma_f32_16x16x32_bf16 v[52:55], v[132:135], v[160:163], v[52:55]
    v_mfma_f32_16x16x32_bf16 v[52:55], v[128:131], v[88:91], v[52:55]
    v_mfma_f32_16x16x32_bf16 v[64:67], v[132:135], v[88:91], v[64:67]
    s_waitcnt lgkmcnt(4)
    v_mfma_f32_16x16x32_bf16 v[64:67], v[136:139], v[160:163], v[64:67]
    v_mfma_f32_16x16x32_bf16 v[64:67], v[140:143], v[172:175], v[64:67]
    s_waitcnt lgkmcnt(3)
    v_mfma_f32_16x16x32_bf16 v[76:79], v[144:147], v[172:175], v[76:79]
    v_mfma_f32_16x16x32_bf16 v[76:79], v[140:143], v[160:163], v[76:79]
    v_mfma_f32_16x16x32_bf16 v[76:79], v[136:139], v[88:91], v[76:79]
    s_waitcnt lgkmcnt(1)
    v_mfma_f32_16x16x32_bf16 v[80:83], v[136:139], v[92:95], v[80:83]
    s_waitcnt lgkmcnt(0)
    v_mfma_f32_16x16x32_bf16 v[80:83], v[140:143], v[164:167], v[80:83]
    v_mfma_f32_16x16x32_bf16 v[80:83], v[144:147], v[176:179], v[80:83]
    v_mfma_f32_16x16x32_bf16 v[68:71], v[140:143], v[176:179], v[68:71]
    v_mfma_f32_16x16x32_bf16 v[68:71], v[136:139], v[164:167], v[68:71]
    v_mfma_f32_16x16x32_bf16 v[68:71], v[132:135], v[92:95], v[68:71]
    s_barrier
    v_mfma_f32_16x16x32_bf16 v[56:59], v[128:131], v[92:95], v[56:59]
    ds_read_b128 v[96:99], v1 offset:2048
    v_mfma_f32_16x16x32_bf16 v[56:59], v[132:135], v[164:167], v[56:59]
    ds_read_b128 v[168:171], v1 offset:8192
    v_mfma_f32_16x16x32_bf16 v[56:59], v[136:139], v[176:179], v[56:59]
    v_mfma_f32_16x16x32_bf16 v[44:47], v[132:135], v[176:179], v[44:47]
    ds_read_b128 v[180:183], v1 offset:14336
    v_mfma_f32_16x16x32_bf16 v[44:47], v[128:131], v[164:167], v[44:47]
    v_mfma_f32_16x16x32_bf16 v[44:47], v[124:127], v[92:95], v[44:47]
    v_mfma_f32_16x16x32_bf16 v[32:35], v[120:123], v[92:95], v[32:35]
    v_mfma_f32_16x16x32_bf16 v[32:35], v[124:127], v[164:167], v[32:35]
    v_mfma_f32_16x16x32_bf16 v[32:35], v[128:131], v[176:179], v[32:35]
    v_mfma_f32_16x16x32_bf16 v[20:23], v[124:127], v[176:179], v[20:23]
    v_mfma_f32_16x16x32_bf16 v[20:23], v[120:123], v[164:167], v[20:23]
    v_mfma_f32_16x16x32_bf16 v[20:23], v[116:119], v[92:95], v[20:23]
    s_waitcnt lgkmcnt(1)
    v_mfma_f32_16x16x32_bf16 v[24:27], v[116:119], v[96:99], v[24:27]
    s_waitcnt lgkmcnt(0)
    v_mfma_f32_16x16x32_bf16 v[24:27], v[120:123], v[168:171], v[24:27]
    v_mfma_f32_16x16x32_bf16 v[24:27], v[124:127], v[180:183], v[24:27]
    v_mfma_f32_16x16x32_bf16 v[36:39], v[128:131], v[180:183], v[36:39]
    v_mfma_f32_16x16x32_bf16 v[36:39], v[124:127], v[168:171], v[36:39]
    v_mfma_f32_16x16x32_bf16 v[36:39], v[120:123], v[96:99], v[36:39]
    s_barrier
    v_mfma_f32_16x16x32_bf16 v[48:51], v[124:127], v[96:99], v[48:51]
    ds_read_b128 v[88:91], v1 offset:18432
    v_mfma_f32_16x16x32_bf16 v[48:51], v[128:131], v[168:171], v[48:51]
    ds_read_b128 v[100:103], v155 offset:26752
    v_mfma_f32_16x16x32_bf16 v[48:51], v[132:135], v[180:183], v[48:51]
    v_mfma_f32_16x16x32_bf16 v[60:63], v[136:139], v[180:183], v[60:63]
    ds_read_b128 v[160:163], v1 offset:24576
    v_mfma_f32_16x16x32_bf16 v[60:63], v[132:135], v[168:171], v[60:63]
    ds_read_b128 v[104:107], v152 offset:40192
    v_mfma_f32_16x16x32_bf16 v[60:63], v[128:131], v[96:99], v[60:63]
    v_mfma_f32_16x16x32_bf16 v[72:75], v[132:135], v[96:99], v[72:75]
    ds_read_b128 v[108:111], v156 offset:26880
    v_mfma_f32_16x16x32_bf16 v[72:75], v[136:139], v[168:171], v[72:75]
    ds_read_b128 v[112:115], v153 offset:40320
    v_mfma_f32_16x16x32_bf16 v[72:75], v[140:143], v[180:183], v[72:75]
    v_mfma_f32_16x16x32_bf16 v[84:87], v[144:147], v[180:183], v[84:87]
    ds_read_b128 v[116:119], v157 offset:27008
    v_mfma_f32_16x16x32_bf16 v[84:87], v[140:143], v[168:171], v[84:87]
    ds_read_b128 v[120:123], v154 offset:40448
    v_mfma_f32_16x16x32_bf16 v[84:87], v[136:139], v[96:99], v[84:87]
    s_waitcnt lgkmcnt(4)
    v_mfma_f32_16x16x32_bf16 v[16:19], v[100:103], v[88:91], v[16:19]
    ds_read_b128 v[124:127], v158 offset:27136
    v_mfma_f32_16x16x32_bf16 v[16:19], v[104:107], v[160:163], v[16:19]
    s_waitcnt lgkmcnt(4)
    v_mfma_f32_16x16x32_bf16 v[28:31], v[104:107], v[88:91], v[28:31]
    ds_read_b128 v[164:167], v1 offset:25600
    v_mfma_f32_16x16x32_bf16 v[28:31], v[108:111], v[160:163], v[28:31]
    s_waitcnt lgkmcnt(4)
    v_mfma_f32_16x16x32_bf16 v[40:43], v[108:111], v[88:91], v[40:43]
    ds_read_b128 v[92:95], v1 offset:19456
    v_mfma_f32_16x16x32_bf16 v[40:43], v[112:115], v[160:163], v[40:43]
    s_barrier
    s_waitcnt lgkmcnt(4)
    v_mfma_f32_16x16x32_bf16 v[52:55], v[112:115], v[88:91], v[52:55]
    v_mfma_f32_16x16x32_bf16 v[52:55], v[116:119], v[160:163], v[52:55]
    s_waitcnt lgkmcnt(3)
    v_mfma_f32_16x16x32_bf16 v[64:67], v[116:119], v[88:91], v[64:67]
    v_mfma_f32_16x16x32_bf16 v[64:67], v[120:123], v[160:163], v[64:67]
    s_waitcnt lgkmcnt(2)
    v_mfma_f32_16x16x32_bf16 v[76:79], v[120:123], v[88:91], v[76:79]
    v_mfma_f32_16x16x32_bf16 v[76:79], v[124:127], v[160:163], v[76:79]
    s_waitcnt lgkmcnt(0)
    v_mfma_f32_16x16x32_bf16 v[80:83], v[124:127], v[164:167], v[80:83]
    ds_read_b128 v[96:99], v1 offset:20480
    v_mfma_f32_16x16x32_bf16 v[80:83], v[120:123], v[92:95], v[80:83]
    v_mfma_f32_16x16x32_bf16 v[68:71], v[120:123], v[164:167], v[68:71]
    ds_read_b128 v[168:171], v1 offset:26624
    v_mfma_f32_16x16x32_bf16 v[68:71], v[116:119], v[92:95], v[68:71]
    v_mfma_f32_16x16x32_bf16 v[56:59], v[116:119], v[164:167], v[56:59]
    v_mfma_f32_16x16x32_bf16 v[56:59], v[112:115], v[92:95], v[56:59]
    v_mfma_f32_16x16x32_bf16 v[44:47], v[112:115], v[164:167], v[44:47]
    v_mfma_f32_16x16x32_bf16 v[44:47], v[108:111], v[92:95], v[44:47]
    v_mfma_f32_16x16x32_bf16 v[32:35], v[108:111], v[164:167], v[32:35]
    v_mfma_f32_16x16x32_bf16 v[32:35], v[104:107], v[92:95], v[32:35]
    v_mfma_f32_16x16x32_bf16 v[20:23], v[104:107], v[164:167], v[20:23]
    v_mfma_f32_16x16x32_bf16 v[20:23], v[100:103], v[92:95], v[20:23]
    s_barrier
    s_waitcnt lgkmcnt(0)
    v_mfma_f32_16x16x32_bf16 v[24:27], v[100:103], v[96:99], v[24:27]
    ds_read_b128 v[88:91], v1 offset:30720
    v_mfma_f32_16x16x32_bf16 v[24:27], v[104:107], v[168:171], v[24:27]
    v_mfma_f32_16x16x32_bf16 v[36:39], v[104:107], v[96:99], v[36:39]
    ds_read_b128 v[160:163], v1 offset:36864
    v_mfma_f32_16x16x32_bf16 v[36:39], v[108:111], v[168:171], v[36:39]
    v_mfma_f32_16x16x32_bf16 v[48:51], v[108:111], v[96:99], v[48:51]
    v_mfma_f32_16x16x32_bf16 v[48:51], v[112:115], v[168:171], v[48:51]
    v_mfma_f32_16x16x32_bf16 v[60:63], v[112:115], v[96:99], v[60:63]
L_pad_m4:
    s_cbranch_scc1 L_ret
    v_mfma_f32_16x16x32_bf16 v[60:63], v[116:119], v[168:171], v[60:63]
    v_mfma_f32_16x16x32_bf16 v[72:75], v[116:119], v[96:99], v[72:75]
    ds_read_b128 v[128:131], v155 offset:40576
    v_mfma_f32_16x16x32_bf16 v[72:75], v[120:123], v[168:171], v[72:75]
    v_mfma_f32_16x16x32_bf16 v[84:87], v[120:123], v[96:99], v[84:87]
    ds_read_b128 v[132:135], v159 offset:27264
    v_mfma_f32_16x16x32_bf16 v[84:87], v[124:127], v[168:171], v[84:87]
    s_waitcnt lgkmcnt(2)
    v_mfma_f32_16x16x32_bf16 v[16:19], v[108:111], v[88:91], v[16:19]
    ds_read_b128 v[164:167], v1 offset:37888
    v_mfma_f32_16x16x32_bf16 v[16:19], v[112:115], v[160:163], v[16:19]
    v_mfma_f32_16x16x32_bf16 v[28:31], v[112:115], v[88:91], v[28:31]
    ds_read_b128 v[92:95], v1 offset:31744
    v_mfma_f32_16x16x32_bf16 v[28:31], v[116:119], v[160:163], v[28:31]
    v_mfma_f32_16x16x32_bf16 v[40:43], v[116:119], v[88:91], v[40:43]
    v_mfma_f32_16x16x32_bf16 v[40:43], v[120:123], v[160:163], v[40:43]
    s_barrier
    v_mfma_f32_16x16x32_bf16 v[52:55], v[120:123], v[88:91], v[52:55]
    v_mfma_f32_16x16x32_bf16 v[52:55], v[124:127], v[160:163], v[52:55]
    s_waitcnt lgkmcnt(3)
    v_mfma_f32_16x16x32_bf16 v[64:67], v[124:127], v[88:91], v[64:67]
    v_mfma_f32_16x16x32_bf16 v[64:67], v[128:131], v[160:163], v[64:67]
    s_waitcnt lgkmcnt(2)
    v_mfma_f32_16x16x32_bf16 v[76:79], v[128:131], v[88:91], v[76:79]
    v_mfma_f32_16x16x32_bf16 v[76:79], v[132:135], v[160:163], v[76:79]
    s_waitcnt lgkmcnt(0)
    v_mfma_f32_16x16x32_bf16 v[80:83], v[132:135], v[164:167], v[80:83]
    ds_read_b128 v[96:99], v1 offset:32768
    v_mfma_f32_16x16x32_bf16 v[80:83], v[128:131], v[92:95], v[80:83]
    v_mfma_f32_16x16x32_bf16 v[68:71], v[128:131], v[164:167], v[68:71]
    ds_read_b128 v[168:171], v1 offset:38912
    v_mfma_f32_16x16x32_bf16 v[68:71], v[124:127], v[92:95], v[68:71]
    v_mfma_f32_16x16x32_bf16 v[56:59], v[124:127], v[164:167], v[56:59]
    v_mfma_f32_16x16x32_bf16 v[56:59], v[120:123], v[92:95], v[56:59]
    v_mfma_f32_16x16x32_bf16 v[44:47], v[120:123], v[164:167], v[44:47]
    v_mfma_f32_16x16x32_bf16 v[44:47], v[116:119], v[92:95], v[44:47]
    v_mfma_f32_16x16x32_bf16 v[32:35], v[116:119], v[164:167], v[32:35]
    v_mfma_f32_16x16x32_bf16 v[32:35], v[112:115], v[92:95], v[32:35]
    v_mfma_f32_16x16x32_bf16 v[20:23], v[112:115], v[164:167], v[20:23]
    v_mfma_f32_16x16x32_bf16 v[20:23], v[108:111], v[92:95], v[20:23]
    s_barrier
    s_waitcnt lgkmcnt(0)
    v_mfma_f32_16x16x32_bf16 v[24:27], v[108:111], v[96:99], v[24:27]
    ds_read_b128 v[88:91], v1 offset:43008
    v_mfma_f32_16x16x32_bf16 v[24:27], v[112:115], v[168:171], v[24:27]
    v_mfma_f32_16x16x32_bf16 v[36:39], v[112:115], v[96:99], v[36:39]
    ds_read_b128 v[160:163], v1 offset:49152
    v_mfma_f32_16x16x32_bf16 v[36:39], v[116:119], v[168:171], v[36:39]
    v_mfma_f32_16x16x32_bf16 v[48:51], v[116:119], v[96:99], v[48:51]
    v_mfma_f32_16x16x32_bf16 v[48:51], v[120:123], v[168:171], v[48:51]
    v_mfma_f32_16x16x32_bf16 v[60:63], v[120:123], v[96:99], v[60:63]
    v_mfma_f32_16x16x32_bf16 v[60:63], v[124:127], v[168:171], v[60:63]
    v_mfma_f32_16x16x32_bf16 v[72:75], v[124:127], v[96:99], v[72:75]
    ds_read_b128 v[136:139], v156 offset:40704
    v_mfma_f32_16x16x32_bf16 v[72:75], v[128:131], v[168:171], v[72:75]
    v_mfma_f32_16x16x32_bf16 v[84:87], v[128:131], v[96:99], v[84:87]
    ds_read_b128 v[140:143], v152 offset:27392
    v_mfma_f32_16x16x32_bf16 v[84:87], v[132:135], v[168:171], v[84:87]
    s_waitcnt lgkmcnt(2)
    v_mfma_f32_16x16x32_bf16 v[16:19], v[116:119], v[88:91], v[16:19]
    ds_read_b128 v[164:167], v1 offset:50176
    v_mfma_f32_16x16x32_bf16 v[16:19], v[120:123], v[160:163], v[16:19]
    v_mfma_f32_16x16x32_bf16 v[28:31], v[120:123], v[88:91], v[28:31]
    ds_read_b128 v[92:95], v1 offset:44032
    v_mfma_f32_16x16x32_bf16 v[28:31], v[124:127], v[160:163], v[28:31]
    v_mfma_f32_16x16x32_bf16 v[40:43], v[124:127], v[88:91], v[40:43]
    v_mfma_f32_16x16x32_bf16 v[40:43], v[128:131], v[160:163], v[40:43]
    s_barrier
    v_mfma_f32_16x16x32_bf16 v[52:55], v[128:131], v[88:91], v[52:55]
    v_mfma_f32_16x16x32_bf16 v[52:55], v[132:135], v[160:163], v[52:55]
    s_waitcnt lgkmcnt(3)
    v_mfma_f32_16x16x32_bf16 v[64:67], v[132:135], v[88:91], v[64:67]
    v_mfma_f32_16x16x32_bf16 v[64:67], v[136:139], v[160:163], v[64:67]
    s_waitcnt lgkmcnt(2)
    v_mfma_f32_16x16x32_bf16 v[76:79], v[136:139], v[88:91], v[76:79]
    v_mfma_f32_16x16x32_bf16 v[76:79], v[140:143], v[160:163], v[76:79]
    s_waitcnt lgkmcnt(0)
    v_mfma_f32_16x16x32_bf16 v[80:83], v[140:143], v[164:167], v[80:83]
    ds_read_b128 v[96:99], v1 offset:45056
    v_mfma_f32_16x16x32_bf16 v[80:83], v[136:139], v[92:95], v[80:83]
    v_mfma_f32_16x16x32_bf16 v[68:71], v[136:139], v[164:167], v[68:71]
    ds_read_b128 v[168:171], v1 offset:51200
    v_mfma_f32_16x16x32_bf16 v[68:71], v[132:135], v[92:95], v[68:71]
    v_mfma_f32_16x16x32_bf16 v[56:59], v[132:135], v[164:167], v[56:59]
    v_mfma_f32_16x16x32_bf16 v[56:59], v[128:131], v[92:95], v[56:59]
    v_mfma_f32_16x16x32_bf16 v[44:47], v[128:131], v[164:167], v[44:47]
    v_mfma_f32_16x16x32_bf16 v[44:47], v[124:127], v[92:95], v[44:47]
    v_mfma_f32_16x16x32_bf16 v[32:35], v[124:127], v[164:167], v[32:35]
    v_mfma_f32_16x16x32_bf16 v[32:35], v[120:123], v[92:95], v[32:35]
    v_mfma_f32_16x16x32_bf16 v[20:23], v[120:123], v[164:167], v[20:23]
    v_mfma_f32_16x16x32_bf16 v[20:23], v[116:119], v[92:95], v[20:23]
    s_barrier
    s_waitcnt lgkmcnt(0)
    v_mfma_f32_16x16x32_bf16 v[24:27], v[116:119], v[96:99], v[24:27]
    ds_read_b128 v[88:91], v1 offset:55296
    v_mfma_f32_16x16x32_bf16 v[24:27], v[120:123], v[168:171], v[24:27]
    v_mfma_f32_16x16x32_bf16 v[36:39], v[120:123], v[96:99], v[36:39]
    ds_read_b128 v[160:163], v1 offset:61440
    v_mfma_f32_16x16x32_bf16 v[36:39], v[124:127], v[168:171], v[36:39]
    v_mfma_f32_16x16x32_bf16 v[48:51], v[124:127], v[96:99], v[48:51]
    v_mfma_f32_16x16x32_bf16 v[48:51], v[128:131], v[168:171], v[48:51]
    v_mfma_f32_16x16x32_bf16 v[60:63], v[128:131], v[96:99], v[60:63]
    v_mfma_f32_16x16x32_bf16 v[60:63], v[132:135], v[168:171], v[60:63]
    v_mfma_f32_16x16x32_bf16 v[72:75], v[132:135], v[96:99], v[72:75]
    ds_read_b128 v[144:147], v157 offset:40832
    v_mfma_f32_16x16x32_bf16 v[72:75], v[136:139], v[168:171], v[72:75]
    v_mfma_f32_16x16x32_bf16 v[84:87], v[136:139], v[96:99], v[84:87]
    ds_read_b128 v[148:151], v153 offset:27520
    v_mfma_f32_16x16x32_bf16 v[84:87], v[140:143], v[168:171], v[84:87]
    s_waitcnt lgkmcnt(2)
    v_mfma_f32_16x16x32_bf16 v[16:19], v[124:127], v[88:91], v[16:19]
    ds_read_b128 v[164:167], v1 offset:62464
    v_mfma_f32_16x16x32_bf16 v[16:19], v[128:131], v[160:163], v[16:19]
    v_mfma_f32_16x16x32_bf16 v[28:31], v[128:131], v[88:91], v[28:31]
    ds_read_b128 v[92:95], v1 offset:56320
    v_mfma_f32_16x16x32_bf16 v[28:31], v[132:135], v[160:163], v[28:31]
    v_mfma_f32_16x16x32_bf16 v[40:43], v[132:135], v[88:91], v[40:43]
    v_mfma_f32_16x16x32_bf16 v[40:43], v[136:139], v[160:163], v[40:43]
    s_barrier
    v_mfma_f32_16x16x32_bf16 v[52:55], v[136:139], v[88:91], v[52:55]
    v_mfma_f32_16x16x32_bf16 v[52:55], v[140:143], v[160:163], v[52:55]
    s_waitcnt lgkmcnt(3)
    v_mfma_f32_16x16x32_bf16 v[64:67], v[140:143], v[88:91], v[64:67]
    v_mfma_f32_16x16x32_bf16 v[64:67], v[144:147], v[160:163], v[64:67]
    s_waitcnt lgkmcnt(2)
    v_mfma_f32_16x16x32_bf16 v[76:79], v[144:147], v[88:91], v[76:79]
    v_mfma_f32_16x16x32_bf16 v[76:79], v[148:151], v[160:163], v[76:79]
    s_waitcnt lgkmcnt(0)
    v_mfma_f32_16x16x32_bf16 v[80:83], v[148:151], v[164:167], v[80:83]
    ds_read_b128 v[96:99], v1 offset:57344
    v_mfma_f32_16x16x32_bf16 v[80:83], v[144:147], v[92:95], v[80:83]
    v_mfma_f32_16x16x32_bf16 v[68:71], v[144:147], v[164:167], v[68:71]
    ds_read_b128 v[168:171], v1 offset:63488
    v_mfma_f32_16x16x32_bf16 v[68:71], v[140:143], v[92:95], v[68:71]
    v_mfma_f32_16x16x32_bf16 v[56:59], v[140:143], v[164:167], v[56:59]
    v_mfma_f32_16x16x32_bf16 v[56:59], v[136:139], v[92:95], v[56:59]
    v_mfma_f32_16x16x32_bf16 v[44:47], v[136:139], v[164:167], v[44:47]
    v_mfma_f32_16x16x32_bf16 v[44:47], v[132:135], v[92:95], v[44:47]
    v_mfma_f32_16x16x32_bf16 v[32:35], v[132:135], v[164:167], v[32:35]
    v_mfma_f32_16x16x32_bf16 v[32:35], v[128:131], v[92:95], v[32:35]
    v_mfma_f32_16x16x32_bf16 v[20:23], v[128:131], v[164:167], v[20:23]
    v_mfma_f32_16x16x32_bf16 v[20:23], v[124:127], v[92:95], v[20:23]
    s_barrier
    s_waitcnt lgkmcnt(0)
    v_mfma_f32_16x16x32_bf16 v[24:27], v[124:127], v[96:99], v[24:27]
    ds_read_b128 v[88:91], v1 offset:0
    v_mfma_f32_16x16x32_bf16 v[24:27], v[128:131], v[168:171], v[24:27]
    v_mfma_f32_16x16x32_bf16 v[36:39], v[128:131], v[96:99], v[36:39]
    ds_read_b128 v[100:103], v156 offset:40192
    v_mfma_f32_16x16x32_bf16 v[36:39], v[132:135], v[168:171], v[36:39]
    v_mfma_f32_16x16x32_bf16 v[48:51], v[132:135], v[96:99], v[48:51]
    ds_read_b128 v[160:163], v1 offset:6144
    v_mfma_f32_16x16x32_bf16 v[48:51], v[136:139], v[168:171], v[48:51]
    v_mfma_f32_16x16x32_bf16 v[60:63], v[136:139], v[96:99], v[60:63]
    ds_read_b128 v[104:107], v152 offset:256
    v_mfma_f32_16x16x32_bf16 v[60:63], v[140:143], v[168:171], v[60:63]
    v_mfma_f32_16x16x32_bf16 v[72:75], v[140:143], v[96:99], v[72:75]
    ds_read_b128 v[108:111], v157 offset:40320
    v_mfma_f32_16x16x32_bf16 v[72:75], v[144:147], v[168:171], v[72:75]
    v_mfma_f32_16x16x32_bf16 v[84:87], v[144:147], v[96:99], v[84:87]
    ds_read_b128 v[112:115], v153 offset:384
    v_mfma_f32_16x16x32_bf16 v[84:87], v[148:151], v[168:171], v[84:87]
    s_waitcnt lgkmcnt(2)
    v_mfma_f32_16x16x32_bf16 v[16:19], v[100:103], v[88:91], v[16:19]
    ds_read_b128 v[116:119], v158 offset:40448
    v_mfma_f32_16x16x32_bf16 v[16:19], v[104:107], v[160:163], v[16:19]
    s_waitcnt lgkmcnt(2)
    v_mfma_f32_16x16x32_bf16 v[28:31], v[104:107], v[88:91], v[28:31]
    ds_read_b128 v[120:123], v154 offset:512
    v_mfma_f32_16x16x32_bf16 v[28:31], v[108:111], v[160:163], v[28:31]
    s_waitcnt lgkmcnt(2)
    v_mfma_f32_16x16x32_bf16 v[40:43], v[108:111], v[88:91], v[40:43]
    ds_read_b128 v[124:127], v159 offset:40576
    v_mfma_f32_16x16x32_bf16 v[40:43], v[112:115], v[160:163], v[40:43]
    s_barrier
    ds_read_b128 v[164:167], v1 offset:7168
    s_waitcnt lgkmcnt(3)
    v_mfma_f32_16x16x32_bf16 v[52:55], v[112:115], v[88:91], v[52:55]
    ds_read_b128 v[92:95], v1 offset:1024
    v_mfma_f32_16x16x32_bf16 v[52:55], v[116:119], v[160:163], v[52:55]
    s_waitcnt lgkmcnt(3)
    v_mfma_f32_16x16x32_bf16 v[64:67], v[116:119], v[88:91], v[64:67]
    v_mfma_f32_16x16x32_bf16 v[64:67], v[120:123], v[160:163], v[64:67]
    s_waitcnt lgkmcnt(2)
    v_mfma_f32_16x16x32_bf16 v[76:79], v[120:123], v[88:91], v[76:79]
    v_mfma_f32_16x16x32_bf16 v[76:79], v[124:127], v[160:163], v[76:79]
    s_waitcnt lgkmcnt(0)
    v_mfma_f32_16x16x32_bf16 v[80:83], v[124:127], v[164:167], v[80:83]
    ds_read_b128 v[96:99], v1 offset:2048
    v_mfma_f32_16x16x32_bf16 v[80:83], v[120:123], v[92:95], v[80:83]
    v_mfma_f32_16x16x32_bf16 v[68:71], v[120:123], v[164:167], v[68:71]
    ds_read_b128 v[168:171], v1 offset:8192
    v_mfma_f32_16x16x32_bf16 v[68:71], v[116:119], v[92:95], v[68:71]
    v_mfma_f32_16x16x32_bf16 v[56:59], v[116:119], v[164:167], v[56:59]
    v_mfma_f32_16x16x32_bf16 v[56:59], v[112:115], v[92:95], v[56:59]
    v_mfma_f32_16x16x32_bf16 v[44:47], v[112:115], v[164:167], v[44:47]
    v_mfma_f32_16x16x32_bf16 v[44:47], v[108:111], v[92:95], v[44:47]
    v_mfma_f32_16x16x32_bf16 v[32:35], v[108:111], v[164:167], v[32:35]
    v_mfma_f32_16x16x32_bf16 v[32:35], v[104:107], v[92:95], v[32:35]
    v_mfma_f32_16x16x32_bf16 v[20:23], v[104:107], v[164:167], v[20:23]
    v_mfma_f32_16x16x32_bf16 v[20:23], v[100:103], v[92:95], v[20:23]
    s_barrier
    s_waitcnt lgkmcnt(0)
    v_mfma_f32_16x16x32_bf16 v[24:27], v[100:103], v[96:99], v[24:27]
    ds_read_b128 v[88:91], v1 offset:12288
    v_mfma_f32_16x16x32_bf16 v[24:27], v[104:107], v[168:171], v[24:27]
    v_mfma_f32_16x16x32_bf16 v[36:39], v[104:107], v[96:99], v[36:39]
    ds_read_b128 v[160:163], v1 offset:18432
    v_mfma_f32_16x16x32_bf16 v[36:39], v[108:111], v[168:171], v[36:39]
    v_mfma_f32_16x16x32_bf16 v[48:51], v[108:111], v[96:99], v[48:51]
    v_mfma_f32_16x16x32_bf16 v[48:51], v[112:115], v[168:171], v[48:51]
    v_mfma_f32_16x16x32_bf16 v[60:63], v[112:115], v[96:99], v[60:63]
    v_mfma_f32_16x16x32_bf16 v[60:63], v[116:119], v[168:171], v[60:63]
    v_mfma_f32_16x16x32_bf16 v[72:75], v[116:119], v[96:99], v[72:75]
    ds_read_b128 v[128:131], v155 offset:640
    v_mfma_f32_16x16x32_bf16 v[72:75], v[120:123], v[168:171], v[72:75]
    v_mfma_f32_16x16x32_bf16 v[84:87], v[120:123], v[96:99], v[84:87]
    ds_read_b128 v[132:135], v152 offset:40704
    v_mfma_f32_16x16x32_bf16 v[84:87], v[124:127], v[168:171], v[84:87]
    s_waitcnt lgkmcnt(2)
    v_mfma_f32_16x16x32_bf16 v[16:19], v[108:111], v[88:91], v[16:19]
    ds_read_b128 v[164:167], v1 offset:19456
    v_mfma_f32_16x16x32_bf16 v[16:19], v[112:115], v[160:163], v[16:19]
    v_mfma_f32_16x16x32_bf16 v[28:31], v[112:115], v[88:91], v[28:31]
    ds_read_b128 v[92:95], v1 offset:13312
    v_mfma_f32_16x16x32_bf16 v[28:31], v[116:119], v[160:163], v[28:31]
    v_mfma_f32_16x16x32_bf16 v[40:43], v[116:119], v[88:91], v[40:43]
    v_mfma_f32_16x16x32_bf16 v[40:43], v[120:123], v[160:163], v[40:43]
    s_barrier
    v_mfma_f32_16x16x32_bf16 v[52:55], v[120:123], v[88:91], v[52:55]
    v_mfma_f32_16x16x32_bf16 v[52:55], v[124:127], v[160:163], v[52:55]
    s_waitcnt lgkmcnt(3)
    v_mfma_f32_16x16x32_bf16 v[64:67], v[124:127], v[88:91], v[64:67]
    v_mfma_f32_16x16x32_bf16 v[64:67], v[128:131], v[160:163], v[64:67]
    s_waitcnt lgkmcnt(2)
    v_mfma_f32_16x16x32_bf16 v[76:79], v[128:131], v[88:91], v[76:79]
    v_mfma_f32_16x16x32_bf16 v[76:79], v[132:135], v[160:163], v[76:79]
    s_waitcnt lgkmcnt(0)
    v_mfma_f32_16x16x32_bf16 v[80:83], v[132:135], v[164:167], v[80:83]
    ds_read_b128 v[96:99], v1 offset:14336
    v_mfma_f32_16x16x32_bf16 v[80:83], v[128:131], v[92:95], v[80:83]
    v_mfma_f32_16x16x32_bf16 v[68:71], v[128:131], v[164:167], v[68:71]
    ds_read_b128 v[168:171], v1 offset:20480
    v_mfma_f32_16x16x32_bf16 v[68:71], v[124:127], v[92:95], v[68:71]
    v_mfma_f32_16x16x32_bf16 v[56:59], v[124:127], v[164:167], v[56:59]
    v_mfma_f32_16x16x32_bf16 v[56:59], v[120:123], v[92:95], v[56:59]
    v_mfma_f32_16x16x32_bf16 v[44:47], v[120:123], v[164:167], v[44:47]
    v_mfma_f32_16x16x32_bf16 v[44:47], v[116:119], v[92:95], v[44:47]
    v_mfma_f32_16x16x32_bf16 v[32:35], v[116:119], v[164:167], v[32:35]
    v_mfma_f32_16x16x32_bf16 v[32:35], v[112:115], v[92:95], v[32:35]
    v_mfma_f32_16x16x32_bf16 v[20:23], v[112:115], v[164:167], v[20:23]
    v_mfma_f32_16x16x32_bf16 v[20:23], v[108:111], v[92:95], v[20:23]
    s_barrier
    s_waitcnt lgkmcnt(0)
    v_mfma_f32_16x16x32_bf16 v[24:27], v[108:111], v[96:99], v[24:27]
    ds_read_b128 v[88:91], v1 offset:24576
    v_mfma_f32_16x16x32_bf16 v[24:27], v[112:115], v[168:171], v[24:27]
    v_mfma_f32_16x16x32_bf16 v[36:39], v[112:115], v[96:99], v[36:39]
    ds_read_b128 v[160:163], v1 offset:30720
    v_mfma_f32_16x16x32_bf16 v[36:39], v[116:119], v[168:171], v[36:39]
    v_mfma_f32_16x16x32_bf16 v[48:51], v[116:119], v[96:99], v[48:51]
    ds_read_b128 v[172:175], v1 offset:36864
    v_mfma_f32_16x16x32_bf16 v[48:51], v[120:123], v[168:171], v[48:51]
    v_mfma_f32_16x16x32_bf16 v[60:63], v[120:123], v[96:99], v[60:63]
    v_mfma_f32_16x16x32_bf16 v[60:63], v[124:127], v[168:171], v[60:63]
    v_mfma_f32_16x16x32_bf16 v[72:75], v[124:127], v[96:99], v[72:75]
    ds_read_b128 v[136:139], v156 offset:768
    v_mfma_f32_16x16x32_bf16 v[72:75], v[128:131], v[168:171], v[72:75]
    v_mfma_f32_16x16x32_bf16 v[84:87], v[128:131], v[96:99], v[84:87]
    v_mfma_f32_16x16x32_bf16 v[84:87], v[132:135], v[168:171], v[84:87]
    s_waitcnt lgkmcnt(2)
    v_mfma_f32_16x16x32_bf16 v[16:19], v[116:119], v[88:91], v[16:19]
    s_waitcnt lgkmcnt(1)
    v_mfma_f32_16x16x32_bf16 v[16:19], v[120:123], v[160:163], v[16:19]
    ds_read_b128 v[140:143], v153 offset:40832
    v_mfma_f32_16x16x32_bf16 v[16:19], v[124:127], v[172:175], v[16:19]
    v_mfma_f32_16x16x32_bf16 v[28:31], v[128:131], v[172:175], v[28:31]
    ds_read_b128 v[144:147], v157 offset:896
    v_mfma_f32_16x16x32_bf16 v[28:31], v[124:127], v[160:163], v[28:31]
    v_mfma_f32_16x16x32_bf16 v[28:31], v[120:123], v[88:91], v[28:31]
    s_barrier
    v_mfma_f32_16x16x32_bf16 v[40:43], v[124:127], v[88:91], v[40:43]
    ds_read_b128 v[92:95], v1 offset:25600
    v_mfma_f32_16x16x32_bf16 v[40:43], v[128:131], v[160:163], v[40:43]
    ds_read_b128 v[164:167], v1 offset:31744
    v_mfma_f32_16x16x32_bf16 v[40:43], v[132:135], v[172:175], v[40:43]
    s_waitcnt lgkmcnt(4)
    v_mfma_f32_16x16x32_bf16 v[52:55], v[136:139], v[172:175], v[52:55]
    ds_read_b128 v[176:179], v1 offset:37888
    v_mfma_f32_16x16x32_bf16 v[52:55], v[132:135], v[160:163], v[52:55]
    v_mfma_f32_16x16x32_bf16 v[52:55], v[128:131], v[88:91], v[52:55]
    v_mfma_f32_16x16x32_bf16 v[64:67], v[132:135], v[88:91], v[64:67]
    s_waitcnt lgkmcnt(4)
    v_mfma_f32_16x16x32_bf16 v[64:67], v[136:139], v[160:163], v[64:67]
    v_mfma_f32_16x16x32_bf16 v[64:67], v[140:143], v[172:175], v[64:67]
    s_waitcnt lgkmcnt(3)
    v_mfma_f32_16x16x32_bf16 v[76:79], v[144:147], v[172:175], v[76:79]
    v_mfma_f32_16x16x32_bf16 v[76:79], v[140:143], v[160:163], v[76:79]
    v_mfma_f32_16x16x32_bf16 v[76:79], v[136:139], v[88:91], v[76:79]
    s_waitcnt lgkmcnt(1)
    v_mfma_f32_16x16x32_bf16 v[80:83], v[136:139], v[92:95], v[80:83]
    s_waitcnt lgkmcnt(0)
    v_mfma_f32_16x16x32_bf16 v[80:83], v[140:143], v[164:167], v[80:83]
    v_mfma_f32_16x16x32_bf16 v[80:83], v[144:147], v[176:179], v[80:83]
    v_mfma_f32_16x16x32_bf16 v[68:71], v[140:143], v[176:179], v[68:71]
    v_mfma_f32_16x16x32_bf16 v[68:71], v[136:139], v[164:167], v[68:71]
    v_mfma_f32_16x16x32_bf16 v[68:71], v[132:135], v[92:95], v[68:71]
    s_barrier
    v_mfma_f32_16x16x32_bf16 v[56:59], v[128:131], v[92:95], v[56:59]
    ds_read_b128 v[96:99], v1 offset:26624
    v_mfma_f32_16x16x32_bf16 v[56:59], v[132:135], v[164:167], v[56:59]
    ds_read_b128 v[168:171], v1 offset:32768
    v_mfma_f32_16x16x32_bf16 v[56:59], v[136:139], v[176:179], v[56:59]
    v_mfma_f32_16x16x32_bf16 v[44:47], v[132:135], v[176:179], v[44:47]
    ds_read_b128 v[180:183], v1 offset:38912
    v_mfma_f32_16x16x32_bf16 v[44:47], v[128:131], v[164:167], v[44:47]
    v_mfma_f32_16x16x32_bf16 v[44:47], v[124:127], v[92:95], v[44:47]
    v_mfma_f32_16x16x32_bf16 v[32:35], v[120:123], v[92:95], v[32:35]
    v_mfma_f32_16x16x32_bf16 v[32:35], v[124:127], v[164:167], v[32:35]
    v_mfma_f32_16x16x32_bf16 v[32:35], v[128:131], v[176:179], v[32:35]
    v_mfma_f32_16x16x32_bf16 v[20:23], v[124:127], v[176:179], v[20:23]
    v_mfma_f32_16x16x32_bf16 v[20:23], v[120:123], v[164:167], v[20:23]
    v_mfma_f32_16x16x32_bf16 v[20:23], v[116:119], v[92:95], v[20:23]
    s_waitcnt lgkmcnt(1)
    v_mfma_f32_16x16x32_bf16 v[24:27], v[116:119], v[96:99], v[24:27]
    s_waitcnt lgkmcnt(0)
    v_mfma_f32_16x16x32_bf16 v[24:27], v[120:123], v[168:171], v[24:27]
    v_mfma_f32_16x16x32_bf16 v[24:27], v[124:127], v[180:183], v[24:27]
    v_mfma_f32_16x16x32_bf16 v[36:39], v[128:131], v[180:183], v[36:39]
    v_mfma_f32_16x16x32_bf16 v[36:39], v[124:127], v[168:171], v[36:39]
    v_mfma_f32_16x16x32_bf16 v[36:39], v[120:123], v[96:99], v[36:39]
    s_barrier
    v_mfma_f32_16x16x32_bf16 v[48:51], v[124:127], v[96:99], v[48:51]
    ds_read_b128 v[88:91], v1 offset:43008
    v_mfma_f32_16x16x32_bf16 v[48:51], v[128:131], v[168:171], v[48:51]
    ds_read_b128 v[100:103], v155 offset:128
    v_mfma_f32_16x16x32_bf16 v[48:51], v[132:135], v[180:183], v[48:51]
    v_mfma_f32_16x16x32_bf16 v[60:63], v[136:139], v[180:183], v[60:63]
    ds_read_b128 v[160:163], v1 offset:49152
    v_mfma_f32_16x16x32_bf16 v[60:63], v[132:135], v[168:171], v[60:63]
    ds_read_b128 v[104:107], v152 offset:13568
    v_mfma_f32_16x16x32_bf16 v[60:63], v[128:131], v[96:99], v[60:63]
    v_mfma_f32_16x16x32_bf16 v[72:75], v[132:135], v[96:99], v[72:75]
    ds_read_b128 v[172:175], v1 offset:55296
    v_mfma_f32_16x16x32_bf16 v[72:75], v[136:139], v[168:171], v[72:75]
    ds_read_b128 v[108:111], v156 offset:256
    v_mfma_f32_16x16x32_bf16 v[72:75], v[140:143], v[180:183], v[72:75]
    ds_read_b128 v[112:115], v153 offset:13696
    v_mfma_f32_16x16x32_bf16 v[84:87], v[144:147], v[180:183], v[84:87]
    ds_read_b128 v[116:119], v157 offset:384
    v_mfma_f32_16x16x32_bf16 v[84:87], v[140:143], v[168:171], v[84:87]
    ds_read_b128 v[120:123], v154 offset:13824
    v_mfma_f32_16x16x32_bf16 v[84:87], v[136:139], v[96:99], v[84:87]
    s_waitcnt lgkmcnt(5)
    v_mfma_f32_16x16x32_bf16 v[16:19], v[100:103], v[88:91], v[16:19]
    s_waitcnt lgkmcnt(3)
    v_mfma_f32_16x16x32_bf16 v[16:19], v[104:107], v[160:163], v[16:19]
    ds_read_b128 v[124:127], v158 offset:512
    v_mfma_f32_16x16x32_bf16 v[16:19], v[108:111], v[172:175], v[16:19]
    s_waitcnt lgkmcnt(3)
    v_mfma_f32_16x16x32_bf16 v[28:31], v[112:115], v[172:175], v[28:31]
    ds_read_b128 v[128:131], v155 offset:13952
    v_mfma_f32_16x16x32_bf16 v[28:31], v[108:111], v[160:163], v[28:31]
    v_mfma_f32_16x16x32_bf16 v[28:31], v[104:107], v[88:91], v[28:31]
    s_barrier
    v_mfma_f32_16x16x32_bf16 v[40:43], v[108:111], v[88:91], v[40:43]
    ds_read_b128 v[92:95], v1 offset:44032
    s_waitcnt lgkmcnt(4)
    v_mfma_f32_16x16x32_bf16 v[40:43], v[112:115], v[160:163], v[40:43]
    ds_read_b128 v[164:167], v1 offset:50176
    v_mfma_f32_16x16x32_bf16 v[40:43], v[116:119], v[172:175], v[40:43]
    s_waitcnt lgkmcnt(4)
    v_mfma_f32_16x16x32_bf16 v[52:55], v[120:123], v[172:175], v[52:55]
    ds_read_b128 v[176:179], v1 offset:56320
    v_mfma_f32_16x16x32_bf16 v[52:55], v[116:119], v[160:163], v[52:55]
    v_mfma_f32_16x16x32_bf16 v[52:55], v[112:115], v[88:91], v[52:55]
    v_mfma_f32_16x16x32_bf16 v[64:67], v[116:119], v[88:91], v[64:67]
    s_waitcnt lgkmcnt(4)
    v_mfma_f32_16x16x32_bf16 v[64:67], v[120:123], v[160:163], v[64:67]
    v_mfma_f32_16x16x32_bf16 v[64:67], v[124:127], v[172:175], v[64:67]
    s_waitcnt lgkmcnt(3)
    v_mfma_f32_16x16x32_bf16 v[76:79], v[128:131], v[172:175], v[76:79]
    v_mfma_f32_16x16x32_bf16 v[76:79], v[124:127], v[160:163], v[76:79]
    v_mfma_f32_16x16x32_bf16 v[76:79], v[120:123], v[88:91], v[76:79]
    s_waitcnt lgkmcnt(1)
    v_mfma_f32_16x16x32_bf16 v[80:83], v[120:123], v[92:95], v[80:83]
    s_waitcnt lgkmcnt(0)
    v_mfma_f32_16x16x32_bf16 v[80:83], v[124:127], v[164:167], v[80:83]
    v_mfma_f32_16x16x32_bf16 v[80:83], v[128:131], v[176:179], v[80:83]
    v_mfma_f32_16x16x32_bf16 v[68:71], v[124:127], v[176:179], v[68:71]
    v_mfma_f32_16x16x32_bf16 v[68:71], v[120:123], v[164:167], v[68:71]
    v_mfma_f32_16x16x32_bf16 v[68:71], v[116:119], v[92:95], v[68:71]
    s_barrier
    v_mfma_f32_16x16x32_bf16 v[56:59], v[112:115], v[92:95], v[56:59]
    ds_read_b128 v[96:99], v1 offset:45056
    v_mfma_f32_16x16x32_bf16 v[56:59], v[116:119], v[164:167], v[56:59]
    ds_read_b128 v[168:171], v1 offset:51200
    v_mfma_f32_16x16x32_bf16 v[56:59], v[120:123], v[176:179], v[56:59]
    v_mfma_f32_16x16x32_bf16 v[44:47], v[116:119], v[176:179], v[44:47]
    ds_read_b128 v[180:183], v1 offset:57344
    v_mfma_f32_16x16x32_bf16 v[44:47], v[112:115], v[164:167], v[44:47]
    v_mfma_f32_16x16x32_bf16 v[44:47], v[108:111], v[92:95], v[44:47]
    v_mfma_f32_16x16x32_bf16 v[32:35], v[104:107], v[92:95], v[32:35]
    v_mfma_f32_16x16x32_bf16 v[32:35], v[108:111], v[164:167], v[32:35]
    v_mfma_f32_16x16x32_bf16 v[32:35], v[112:115], v[176:179], v[32:35]
    v_mfma_f32_16x16x32_bf16 v[20:23], v[108:111], v[176:179], v[20:23]
    v_mfma_f32_16x16x32_bf16 v[20:23], v[104:107], v[164:167], v[20:23]
    v_mfma_f32_16x16x32_bf16 v[20:23], v[100:103], v[92:95], v[20:23]
    s_waitcnt lgkmcnt(1)
    v_mfma_f32_16x16x32_bf16 v[24:27], v[100:103], v[96:99], v[24:27]
    s_waitcnt lgkmcnt(0)
    v_mfma_f32_16x16x32_bf16 v[24:27], v[104:107], v[168:171], v[24:27]
    v_mfma_f32_16x16x32_bf16 v[24:27], v[108:111], v[180:183], v[24:27]
    v_mfma_f32_16x16x32_bf16 v[36:39], v[112:115], v[180:183], v[36:39]
    v_mfma_f32_16x16x32_bf16 v[36:39], v[108:111], v[168:171], v[36:39]
    v_mfma_f32_16x16x32_bf16 v[36:39], v[104:107], v[96:99], v[36:39]
    s_barrier
    ds_read_b128 v[88:91], v1 offset:61440
    v_mfma_f32_16x16x32_bf16 v[48:51], v[108:111], v[96:99], v[48:51]
    ds_read_b128 v[160:163], v1 offset:0
    v_mfma_f32_16x16x32_bf16 v[48:51], v[112:115], v[168:171], v[48:51]
    ds_read_b128 v[172:175], v1 offset:6144
    v_mfma_f32_16x16x32_bf16 v[48:51], v[116:119], v[180:183], v[48:51]
    ds_read_b128 v[184:187], v1 offset:12288
    v_mfma_f32_16x16x32_bf16 v[60:63], v[120:123], v[180:183], v[60:63]
    ds_read_b128 v[196:199], v1 offset:18432
    v_mfma_f32_16x16x32_bf16 v[60:63], v[116:119], v[168:171], v[60:63]
    ds_read_b128 v[132:135], v159 offset:640
    v_mfma_f32_16x16x32_bf16 v[60:63], v[112:115], v[96:99], v[60:63]
    v_mfma_f32_16x16x32_bf16 v[72:75], v[116:119], v[96:99], v[72:75]
    v_mfma_f32_16x16x32_bf16 v[72:75], v[120:123], v[168:171], v[72:75]
    v_mfma_f32_16x16x32_bf16 v[72:75], v[124:127], v[180:183], v[72:75]
    v_mfma_f32_16x16x32_bf16 v[84:87], v[128:131], v[180:183], v[84:87]
    v_mfma_f32_16x16x32_bf16 v[84:87], v[124:127], v[168:171], v[84:87]
    v_mfma_f32_16x16x32_bf16 v[84:87], v[120:123], v[96:99], v[84:87]
    s_waitcnt lgkmcnt(4)
    v_mfma_f32_16x16x32_bf16 v[16:19], v[112:115], v[88:91], v[16:19]
    s_waitcnt lgkmcnt(3)
    v_mfma_f32_16x16x32_bf16 v[16:19], v[116:119], v[160:163], v[16:19]
    ds_read_b128 v[136:139], v156 offset:14080
    s_waitcnt lgkmcnt(3)
    v_mfma_f32_16x16x32_bf16 v[16:19], v[120:123], v[172:175], v[16:19]
    ds_read_b128 v[92:95], v1 offset:62464
    s_waitcnt lgkmcnt(3)
    v_mfma_f32_16x16x32_bf16 v[16:19], v[124:127], v[184:187], v[16:19]
    ds_read_b128 v[164:167], v1 offset:1024
    v_mfma_f32_16x16x32_bf16 v[16:19], v[128:131], v[196:199], v[16:19]
    ds_read_b128 v[176:179], v1 offset:7168
    s_waitcnt lgkmcnt(4)
    v_mfma_f32_16x16x32_bf16 v[28:31], v[132:135], v[196:199], v[28:31]
    ds_read_b128 v[188:191], v1 offset:13312
    v_mfma_f32_16x16x32_bf16 v[28:31], v[128:131], v[184:187], v[28:31]
    ds_read_b128 v[200:203], v1 offset:19456
    v_mfma_f32_16x16x32_bf16 v[28:31], v[124:127], v[172:175], v[28:31]
    v_mfma_f32_16x16x32_bf16 v[28:31], v[120:123], v[160:163], v[28:31]
    v_mfma_f32_16x16x32_bf16 v[28:31], v[116:119], v[88:91], v[28:31]
    v_mfma_f32_16x16x32_bf16 v[40:43], v[120:123], v[88:91], v[40:43]
    v_mfma_f32_16x16x32_bf16 v[40:43], v[124:127], v[160:163], v[40:43]
    v_mfma_f32_16x16x32_bf16 v[40:43], v[128:131], v[172:175], v[40:43]
    ds_write_b128 v5, v[16:19] offset:18432
    s_waitcnt lgkmcnt(6)
    v_mfma_f32_16x16x32_bf16 v[40:43], v[132:135], v[184:187], v[40:43]
    v_mfma_f32_16x16x32_bf16 v[40:43], v[136:139], v[196:199], v[40:43]
    s_waitcnt lgkmcnt(4)
    v_mfma_f32_16x16x32_bf16 v[20:23], v[112:115], v[92:95], v[20:23]
    s_waitcnt lgkmcnt(3)
    v_mfma_f32_16x16x32_bf16 v[20:23], v[116:119], v[164:167], v[20:23]
    s_waitcnt lgkmcnt(2)
    v_mfma_f32_16x16x32_bf16 v[20:23], v[120:123], v[176:179], v[20:23]
    ds_write_b128 v5, v[28:31] offset:19456
    s_waitcnt lgkmcnt(2)
    v_mfma_f32_16x16x32_bf16 v[20:23], v[124:127], v[188:191], v[20:23]
    ds_read_b128 v[96:99], v1 offset:63488
    v_mfma_f32_16x16x32_bf16 v[20:23], v[128:131], v[200:203], v[20:23]
    ds_read_b128 v[168:171], v1 offset:2048
    v_mfma_f32_16x16x32_bf16 v[32:35], v[132:135], v[200:203], v[32:35]
    ds_read_b128 v[180:183], v1 offset:8192
    v_mfma_f32_16x16x32_bf16 v[32:35], v[128:131], v[188:191], v[32:35]
    ds_read_b128 v[192:195], v1 offset:14336
    v_mfma_f32_16x16x32_bf16 v[32:35], v[124:127], v[176:179], v[32:35]
    ds_write_b128 v5, v[40:43] offset:20480
    v_mfma_f32_16x16x32_bf16 v[32:35], v[120:123], v[164:167], v[32:35]
    ds_read_b128 v[204:207], v1 offset:20480
    v_mfma_f32_16x16x32_bf16 v[32:35], v[116:119], v[92:95], v[32:35]
    v_mfma_f32_16x16x32_bf16 v[44:47], v[120:123], v[92:95], v[44:47]
    v_mfma_f32_16x16x32_bf16 v[44:47], v[124:127], v[164:167], v[44:47]
    v_mfma_f32_16x16x32_bf16 v[44:47], v[128:131], v[176:179], v[44:47]
    ds_write_b128 v5, v[20:23] offset:21504
    v_mfma_f32_16x16x32_bf16 v[44:47], v[132:135], v[188:191], v[44:47]
    v_mfma_f32_16x16x32_bf16 v[44:47], v[136:139], v[200:203], v[44:47]
    s_waitcnt lgkmcnt(5)
    v_mfma_f32_16x16x32_bf16 v[24:27], v[112:115], v[96:99], v[24:27]
    s_waitcnt lgkmcnt(4)
    v_mfma_f32_16x16x32_bf16 v[24:27], v[116:119], v[168:171], v[24:27]
    s_waitcnt lgkmcnt(3)
    v_mfma_f32_16x16x32_bf16 v[24:27], v[120:123], v[180:183], v[24:27]
    ds_write_b128 v5, v[32:35] offset:22528
    s_waitcnt lgkmcnt(2)
    v_mfma_f32_16x16x32_bf16 v[24:27], v[124:127], v[192:195], v[24:27]
    v_mfma_f32_16x16x32_bf16 v[24:27], v[128:131], v[204:207], v[24:27]
    v_mfma_f32_16x16x32_bf16 v[36:39], v[132:135], v[204:207], v[36:39]
    v_mfma_f32_16x16x32_bf16 v[36:39], v[128:131], v[192:195], v[36:39]
    ds_read_b128 v[140:143], v152 offset:768
    v_mfma_f32_16x16x32_bf16 v[36:39], v[124:127], v[180:183], v[36:39]
    ds_write_b128 v5, v[44:47] offset:23552
    v_mfma_f32_16x16x32_bf16 v[36:39], v[120:123], v[168:171], v[36:39]
    ds_read_b128 v[144:147], v157 offset:14208
    v_mfma_f32_16x16x32_bf16 v[36:39], v[116:119], v[96:99], v[36:39]
    s_waitcnt lgkmcnt(3)
    s_barrier
    ds_read_b128 v[16:19], v5 offset:0
    v_mfma_f32_16x16x32_bf16 v[48:51], v[120:123], v[96:99], v[48:51]
    ds_read_b128 v[28:31], v5 offset:1024
    v_mfma_f32_16x16x32_bf16 v[48:51], v[124:127], v[168:171], v[48:51]
    ds_read_b128 v[40:43], v5 offset:2048
    v_mfma_f32_16x16x32_bf16 v[48:51], v[128:131], v[180:183], v[48:51]
    ds_write_b128 v5, v[24:27] offset:24576
    v_mfma_f32_16x16x32_bf16 v[48:51], v[132:135], v[192:195], v[48:51]
    ds_read_b128 v[20:23], v5 offset:3072
    v_mfma_f32_16x16x32_bf16 v[48:51], v[136:139], v[204:207], v[48:51]
    ds_read_b128 v[32:35], v5 offset:4096
    v_mfma_f32_16x16x32_bf16 v[52:55], v[124:127], v[88:91], v[52:55]
    v_mfma_f32_16x16x32_bf16 v[52:55], v[128:131], v[160:163], v[52:55]
    ds_read_b128 v[148:151], v153 offset:896
    s_waitcnt lgkmcnt(5)
    v_add_f32 v64, v64, v28
    v_mfma_f32_16x16x32_bf16 v[52:55], v[132:135], v[172:175], v[52:55]
    ds_write_b128 v5, v[36:39] offset:25600
    v_add_f32 v65, v65, v29
    v_mfma_f32_16x16x32_bf16 v[52:55], v[136:139], v[184:187], v[52:55]
    v_add_f32 v66, v66, v30
    v_add_f32 v67, v67, v31
    v_mfma_f32_16x16x32_bf16 v[52:55], v[140:143], v[196:199], v[52:55]
    s_waitcnt lgkmcnt(5)
    v_add_f32 v76, v76, v40
    v_add_f32 v77, v77, v41
    v_mfma_f32_16x16x32_bf16 v[64:67], v[144:147], v[196:199], v[64:67]
    v_add_f32 v78, v78, v42
    v_add_f32 v79, v79, v43
    v_mfma_f32_16x16x32_bf16 v[64:67], v[140:143], v[184:187], v[64:67]
    s_waitcnt lgkmcnt(3)
    v_add_f32 v56, v56, v20
    v_add_f32 v57, v57, v21
    v_mfma_f32_16x16x32_bf16 v[64:67], v[136:139], v[172:175], v[64:67]
    ds_write_b128 v5, v[48:51] offset:26624
    v_add_f32 v58, v58, v22
    v_mfma_f32_16x16x32_bf16 v[64:67], v[132:135], v[160:163], v[64:67]
    v_add_f32 v59, v59, v23
    s_waitcnt lgkmcnt(3)
    v_add_f32 v68, v68, v32
    v_mfma_f32_16x16x32_bf16 v[64:67], v[128:131], v[88:91], v[64:67]
    v_add_f32 v69, v69, v33
    v_add_f32 v70, v70, v34
    v_mfma_f32_16x16x32_bf16 v[76:79], v[132:135], v[88:91], v[76:79]
    v_add_f32 v71, v71, v35
    v_add_f32 v52, v52, v16
    v_mfma_f32_16x16x32_bf16 v[76:79], v[136:139], v[160:163], v[76:79]
    v_add_f32 v53, v53, v17
    v_add_f32 v54, v54, v18
    v_mfma_f32_16x16x32_bf16 v[76:79], v[140:143], v[172:175], v[76:79]
    v_add_f32 v55, v55, v19
    v_add_f32 v232, v52, v53
    s_waitcnt lgkmcnt(2)
    v_mfma_f32_16x16x32_bf16 v[76:79], v[144:147], v[184:187], v[76:79]
    v_mul_f32 v233, v52, v52
L_pad_m5:
    s_cbranch_scc1 L_ret
    v_fmac_f32 v233, v53, v53
    v_mfma_f32_16x16x32_bf16 v[76:79], v[148:151], v[196:199], v[76:79]
    s_waitcnt lgkmcnt(0)
    s_barrier
    ds_read_b128 v[44:47], v5 offset:5120
    v_add_f32 v232, v232, v54
    v_mfma_f32_16x16x32_bf16 v[56:59], v[124:127], v[92:95], v[56:59]
    ds_read_b128 v[24:27], v5 offset:6144
    v_fmac_f32 v233, v54, v54
    v_mfma_f32_16x16x32_bf16 v[56:59], v[128:131], v[164:167], v[56:59]
    ds_read_b128 v[36:39], v5 offset:7168
    v_add_f32 v232, v232, v55
    v_mfma_f32_16x16x32_bf16 v[56:59], v[132:135], v[176:179], v[56:59]
    ds_read_b128 v[48:51], v5 offset:8192
    v_fmac_f32 v233, v55, v55
    v_mfma_f32_16x16x32_bf16 v[56:59], v[136:139], v[188:191], v[56:59]
    v_add_f32 v232, v232, v64
    v_fmac_f32 v233, v64, v64
    v_mfma_f32_16x16x32_bf16 v[56:59], v[140:143], v[200:203], v[56:59]
    v_add_f32 v232, v232, v65
    v_fmac_f32 v233, v65, v65
    v_mfma_f32_16x16x32_bf16 v[68:71], v[144:147], v[200:203], v[68:71]
    s_waitcnt lgkmcnt(3)
    v_add_f32 v80, v80, v44
    v_add_f32 v81, v81, v45
    v_mfma_f32_16x16x32_bf16 v[68:71], v[140:143], v[188:191], v[68:71]
    v_add_f32 v82, v82, v46
    v_add_f32 v83, v83, v47
    v_mfma_f32_16x16x32_bf16 v[68:71], v[136:139], v[176:179], v[68:71]
    s_waitcnt lgkmcnt(2)
    v_add_f32 v60, v60, v24
    v_add_f32 v61, v61, v25
    v_mfma_f32_16x16x32_bf16 v[68:71], v[132:135], v[164:167], v[68:71]
    v_add_f32 v62, v62, v26
    v_add_f32 v63, v63, v27
    v_mfma_f32_16x16x32_bf16 v[68:71], v[128:131], v[92:95], v[68:71]
    s_waitcnt lgkmcnt(1)
    v_add_f32 v72, v72, v36
    v_add_f32 v73, v73, v37
    v_mfma_f32_16x16x32_bf16 v[80:83], v[132:135], v[92:95], v[80:83]
    v_add_f32 v74, v74, v38
    v_add_f32 v75, v75, v39
    v_mfma_f32_16x16x32_bf16 v[80:83], v[136:139], v[164:167], v[80:83]
    s_waitcnt lgkmcnt(0)
    v_add_f32 v84, v84, v48
    v_add_f32 v85, v85, v49
    v_mfma_f32_16x16x32_bf16 v[80:83], v[140:143], v[176:179], v[80:83]
    v_add_f32 v86, v86, v50
    v_add_f32 v87, v87, v51
    v_mfma_f32_16x16x32_bf16 v[80:83], v[144:147], v[188:191], v[80:83]
    v_add_f32 v232, v232, v66
    v_fmac_f32 v233, v66, v66
    v_mfma_f32_16x16x32_bf16 v[80:83], v[148:151], v[200:203], v[80:83]
    v_add_f32 v232, v232, v67
    v_fmac_f32 v233, v67, v67
    v_mfma_f32_16x16x32_bf16 v[60:63], v[124:127], v[96:99], v[60:63]
    v_cndmask_b32 v78, 0, v78, s[54:55]
    v_add_f32 v232, v232, v76
    v_mfma_f32_16x16x32_bf16 v[60:63], v[128:131], v[168:171], v[60:63]
    v_fmac_f32 v233, v76, v76
    v_add_f32 v232, v232, v77
    v_mfma_f32_16x16x32_bf16 v[60:63], v[132:135], v[180:183], v[60:63]
    v_fmac_f32 v233, v77, v77
    v_add_f32 v232, v232, v78
    v_mfma_f32_16x16x32_bf16 v[60:63], v[136:139], v[192:195], v[60:63]
    v_fmac_f32 v233, v78, v78
    v_add_f32 v232, v232, v79
    v_mfma_f32_16x16x32_bf16 v[60:63], v[140:143], v[204:207], v[60:63]
    s_barrier
    v_fmac_f32 v233, v79, v79
    v_add_f32 v234, v56, v57
    v_mfma_f32_16x16x32_bf16 v[72:75], v[144:147], v[204:207], v[72:75]
    v_mul_f32 v235, v56, v56
    v_fmac_f32 v235, v57, v57
    v_mfma_f32_16x16x32_bf16 v[72:75], v[140:143], v[192:195], v[72:75]
    v_add_f32 v234, v234, v58
    v_fmac_f32 v235, v58, v58
    v_mfma_f32_16x16x32_bf16 v[72:75], v[136:139], v[180:183], v[72:75]
    v_add_f32 v234, v234, v59
    v_fmac_f32 v235, v59, v59
    v_mfma_f32_16x16x32_bf16 v[72:75], v[132:135], v[168:171], v[72:75]
    v_add_f32 v234, v234, v68
    v_fmac_f32 v235, v68, v68
    v_mfma_f32_16x16x32_bf16 v[72:75], v[128:131], v[96:99], v[72:75]
    v_add_f32 v234, v234, v69
    v_fmac_f32 v235, v69, v69
    v_mfma_f32_16x16x32_bf16 v[84:87], v[132:135], v[96:99], v[84:87]
    v_add_f32 v234, v234, v70
    v_fmac_f32 v235, v70, v70
    v_mfma_f32_16x16x32_bf16 v[84:87], v[136:139], v[168:171], v[84:87]
    v_add_f32 v234, v234, v71
    v_fmac_f32 v235, v71, v71
    v_mfma_f32_16x16x32_bf16 v[84:87], v[140:143], v[180:183], v[84:87]
    v_cndmask_b32 v82, 0, v82, s[54:55]
    v_add_f32 v234, v234, v80
    v_mfma_f32_16x16x32_bf16 v[84:87], v[144:147], v[192:195], v[84:87]
    v_fmac_f32 v235, v80, v80
    v_add_f32 v234, v234, v81
    v_mfma_f32_16x16x32_bf16 v[84:87], v[148:151], v[204:207], v[84:87]
    v_fmac_f32 v235, v81, v81
    v_add_f32 v234, v234, v82
    v_fmac_f32 v235, v82, v82
    v_add_f32 v234, v234, v83
    v_fmac_f32 v235, v83, v83
    v_add_f32 v236, v60, v61
    v_mul_f32 v237, v60, v60
    v_fmac_f32 v237, v61, v61
    v_add_f32 v236, v236, v62
    v_fmac_f32 v237, v62, v62
    v_add_f32 v236, v236, v63
    v_fmac_f32 v237, v63, v63
    v_add_f32 v236, v236, v72
    v_fmac_f32 v237, v72, v72
    v_add_f32 v236, v236, v73
    v_fmac_f32 v237, v73, v73
    v_add_f32 v236, v236, v74
    v_fmac_f32 v237, v74, v74
    v_add_f32 v236, v236, v75
    v_fmac_f32 v237, v75, v75
    v_cndmask_b32 v86, 0, v86, s[54:55]
    v_add_f32 v236, v236, v84
    v_fmac_f32 v237, v84, v84
    v_add_f32 v236, v236, v85
    v_fmac_f32 v237, v85, v85
    v_add_f32 v236, v236, v86
    v_fmac_f32 v237, v86, v86
    v_add_f32 v236, v236, v87
    v_fmac_f32 v237, v87, v87
    v_permlane32_swap_b32 v232, v233
    v_permlane32_swap_b32 v234, v235
    v_permlane32_swap_b32 v236, v237
    v_add_f32 v232, v232, v233
    v_add_f32 v234, v234, v235
    v_add_f32 v236, v236, v237
    v_mov_b32 v237, v236
    v_permlane16_swap_b32 v232, v234
    v_add_f32 v232, v232, v234
    v_permlane16_swap_b32 v236, v237
    v_add_f32 v236, v236, v237
    ds_write2_b32 v7, v232, v236 offset1:64
    s_setprio 0
    s_waitcnt lgkmcnt(0)
    s_barrier
    v_add_u32 v10, 1152, v6
    v_add_u32 v11, 2304, v6
    v_add_u32 v12, 3456, v6
    s_barrier
    ds_write2_b32 v6, v52, v56 offset0:0 offset1:16
    ds_write2_b32 v6, v60, v64 offset0:32 offset1:48
    ds_write2_b32 v6, v68, v72 offset0:64 offset1:80
    ds_write2_b32 v6, v76, v80 offset0:96 offset1:112
    ds_write_b32 v6, v84 offset:512
    ds_write2_b32 v10, v53, v57 offset0:0 offset1:16
    ds_write2_b32 v10, v61, v65 offset0:32 offset1:48
    ds_write2_b32 v10, v69, v73 offset0:64 offset1:80
    ds_write2_b32 v10, v77, v81 offset0:96 offset1:112
    ds_write_b32 v10, v85 offset:512
    ds_write2_b32 v11, v54, v58 offset0:0 offset1:16
    ds_write2_b32 v11, v62, v66 offset0:32 offset1:48
    ds_write2_b32 v11, v70, v74 offset0:64 offset1:80
    ds_write2_b32 v11, v78, v82 offset0:96 offset1:112
    ds_write_b32 v11, v86 offset:512
    ds_write2_b32 v12, v55, v59 offset0:0 offset1:16
    ds_write2_b32 v12, v63, v67 offset0:32 offset1:48
    ds_write2_b32 v12, v71, v75 offset0:64 offset1:80
    ds_write2_b32 v12, v79, v83 offset0:96 offset1:112
    ds_write_b32 v12, v87 offset:512
    s_waitcnt lgkmcnt(0)
    s_barrier
    ds_read_b64 v[100:101], v4 offset:0
    ds_read_b64 v[102:103], v4 offset:8
    ds_read_b64 v[104:105], v4 offset:16
    ds_read_b64 v[106:107], v4 offset:1536
    ds_read_b64 v[108:109], v4 offset:1544
    ds_read_b64 v[110:111], v4 offset:1552
    ds_read_b64 v[112:113], v4 offset:3072
    ds_read_b64 v[114:115], v4 offset:3080
    ds_read_b64 v[116:117], v4 offset:3088
L_final:
    v_mov_b32 v14, 0xc0135761
    v_mov_b32 v15, v14
    s_mov_b32 s49, 0xbdd2d3e8
    s_mov_b32 s48, s49
    s_movk_i32 s45, 4608
    s_waitcnt lgkmcnt(0)
    s_barrier
    ds_read_b128 v[140:143], v8 offset:0
    ds_read_b128 v[144:147], v8 offset:16
    ds_read_b128 v[148:151], v8 offset:32
    s_waitcnt lgkmcnt(0)
    v_pk_fma_f32 v[100:101], v[100:101], v[140:141], v[146:147]
    v_pk_fma_f32 v[102:103], v[102:103], v[142:143], v[148:149]
    v_pk_fma_f32 v[104:105], v[104:105], v[144:145], v[150:151]
    v_pk_mul_f32 v[120:121], v[100:101], v[100:101]
    v_pk_mul_f32 v[122:123], v[102:103], v[102:103]
    v_pk_mul_f32 v[124:125], v[104:105], v[104:105]
    v_pk_fma_f32 v[120:121], v[120:121], s[48:49], v[14:15]
    v_pk_fma_f32 v[122:123], v[122:123], s[48:49], v[14:15]
    v_pk_fma_f32 v[124:125], v[124:125], s[48:49], v[14:15]
    v_pk_mul_f32 v[120:121], v[120:121], v[100:101]
    v_pk_mul_f32 v[122:123], v[122:123], v[102:103]
    v_pk_mul_f32 v[124:125], v[124:125], v[104:105]
    v_exp_f32 v120, v120
    v_exp_f32 v121, v121
    v_exp_f32 v122, v122
    v_exp_f32 v123, v123
    v_exp_f32 v124, v124
    v_exp_f32 v125, v125
    v_pk_add_f32 v[120:121], v[120:121], 1.0 op_sel_hi:[1,0]
    v_pk_add_f32 v[122:123], v[122:123], 1.0 op_sel_hi:[1,0]
    v_pk_add_f32 v[124:125], v[124:125], 1.0 op_sel_hi:[1,0]
    v_rcp_f32 v120, v120
    v_rcp_f32 v121, v121
    v_rcp_f32 v122, v122
    v_rcp_f32 v123, v123
    v_rcp_f32 v124, v124
    v_rcp_f32 v125, v125
    v_pk_mul_f32 v[120:121], v[120:121], v[100:101]
    v_pk_mul_f32 v[122:123], v[122:123], v[102:103]
    v_pk_mul_f32 v[124:125], v[124:125], v[104:105]
    v_cvt_pk_bf16_f32 v152, v120, v121
    v_cvt_pk_bf16_f32 v153, v122, v123
    v_cvt_pk_bf16_f32 v154, v124, v125
    buffer_store_dwordx3 v[152:154], v3, s[28:31], 0 offen offset:0 sc1
    v_pk_fma_f32 v[106:107], v[106:107], v[140:141], v[146:147]
    v_pk_fma_f32 v[108:109], v[108:109], v[142:143], v[148:149]
    v_pk_fma_f32 v[110:111], v[110:111], v[144:145], v[150:151]
    v_pk_mul_f32 v[126:127], v[106:107], v[106:107]
    v_pk_mul_f32 v[128:129], v[108:109], v[108:109]
    v_pk_mul_f32 v[130:131], v[110:111], v[110:111]
    v_pk_fma_f32 v[126:127], v[126:127], s[48:49], v[14:15]
    v_pk_fma_f32 v[128:129], v[128:129], s[48:49], v[14:15]
    v_pk_fma_f32 v[130:131], v[130:131], s[48:49], v[14:15]
    v_pk_mul_f32 v[126:127], v[126:127], v[106:107]
    v_pk_mul_f32 v[128:129], v[128:129], v[108:109]
    v_pk_mul_f32 v[130:131], v[130:131], v[110:111]
    v_exp_f32 v126, v126
    v_exp_f32 v127, v127
    v_exp_f32 v128, v128
    v_exp_f32 v129, v129
    v_exp_f32 v130, v130
    v_exp_f32 v131, v131
    v_pk_add_f32 v[126:127], v[126:127], 1.0 op_sel_hi:[1,0]
    v_pk_add_f32 v[128:129], v[128:129], 1.0 op_sel_hi:[1,0]
    v_pk_add_f32 v[130:131], v[130:131], 1.0 op_sel_hi:[1,0]
    v_rcp_f32 v126, v126
    v_rcp_f32 v127, v127
    v_rcp_f32 v128, v128
    v_rcp_f32 v129, v129
    v_rcp_f32 v130, v130
    v_rcp_f32 v131, v131
    v_pk_mul_f32 v[126:127], v[126:127], v[106:107]
    v_pk_mul_f32 v[128:129], v[128:129], v[108:109]
    v_pk_mul_f32 v[130:131], v[130:131], v[110:111]
    v_cvt_pk_bf16_f32 v156, v126, v127
    v_cvt_pk_bf16_f32 v157, v128, v129
    v_cvt_pk_bf16_f32 v158, v130, v131
    buffer_store_dwordx3 v[156:158], v3, s[28:31], 0 offen offset:2304 sc1
    v_pk_fma_f32 v[112:113], v[112:113], v[140:141], v[146:147]
    v_pk_fma_f32 v[114:115], v[114:115], v[142:143], v[148:149]
    v_pk_fma_f32 v[116:117], v[116:117], v[144:145], v[150:151]
    v_pk_mul_f32 v[132:133], v[112:113], v[112:113]
    v_pk_mul_f32 v[134:135], v[114:115], v[114:115]
    v_pk_mul_f32 v[136:137], v[116:117], v[116:117]
    v_pk_fma_f32 v[132:133], v[132:133], s[48:49], v[14:15]
    v_pk_fma_f32 v[134:135], v[134:135], s[48:49], v[14:15]
    v_pk_fma_f32 v[136:137], v[136:137], s[48:49], v[14:15]
    v_pk_mul_f32 v[132:133], v[132:133], v[112:113]
    v_pk_mul_f32 v[134:135], v[134:135], v[114:115]
    v_pk_mul_f32 v[136:137], v[136:137], v[116:117]
    v_exp_f32 v132, v132
    v_exp_f32 v133, v133
    v_exp_f32 v134, v134
    v_exp_f32 v135, v135
    v_exp_f32 v136, v136
    v_exp_f32 v137, v137
    v_pk_add_f32 v[132:133], v[132:133], 1.0 op_sel_hi:[1,0]
    v_pk_add_f32 v[134:135], v[134:135], 1.0 op_sel_hi:[1,0]
    v_pk_add_f32 v[136:137], v[136:137], 1.0 op_sel_hi:[1,0]
    v_rcp_f32 v132, v132
    v_rcp_f32 v133, v133
    v_rcp_f32 v134, v134
    v_rcp_f32 v135, v135
    v_rcp_f32 v136, v136
    v_rcp_f32 v137, v137
    v_pk_mul_f32 v[132:133], v[132:133], v[112:113]
    v_pk_mul_f32 v[134:135], v[134:135], v[114:115]
    v_pk_mul_f32 v[136:137], v[136:137], v[116:117]
    v_cvt_pk_bf16_f32 v160, v132, v133
    v_cvt_pk_bf16_f32 v161, v134, v135
    v_cvt_pk_bf16_f32 v162, v136, v137
    buffer_store_dwordx3 v[160:162], v3, s[28:31], s45 offen offset:0 sc1
L_end:
    s_endpgm
L_pad_f:
    s_branch L_ret
L_publish:
    s_waitcnt lgkmcnt(0)
    s_barrier
    s_barrier
    s_mov_b32 exec_hi, 1023
    s_bitset0_b64 exec, s43
    s_barrier
    buffer_atomic_add v24, v12, s[32:35], 0 offen offset:384 sc1
    s_mov_b32 exec_lo, -1
    s_mov_b32 exec_hi, 0xffff
    s_setprio 3
    s_barrier
    ds_read_b64 v[16:17], v6 offset:0
    ds_read_b64 v[18:19], v6 offset:512
    ds_read_b64 v[20:21], v6 offset:1024
    ds_read_b64 v[22:23], v6 offset:1536
    s_waitcnt lgkmcnt(2)
    v_add_f32 v16, v16, v18
    v_add_f32 v17, v17, v19
    s_waitcnt lgkmcnt(0)
    v_add_f32 v20, v20, v22
    v_add_f32 v21, v21, v23
    v_add_f32 v16, v16, v20
    v_add_f32 v17, v17, v21
    v_min_u32 v16, -2, v16
    v_min_u32 v17, -2, v17
    buffer_store_dwordx2 v[16:17], v5, s[32:35], s47 offen sc1
    s_setprio 0
    s_barrier
    s_mov_b64 exec, -1
    s_barrier
    ds_read_b64 v[100:101], v4 offset:0
    ds_read_b64 v[102:103], v4 offset:8
    ds_read_b64 v[104:105], v4 offset:16
    ds_read_b64 v[106:107], v4 offset:1536
    ds_read_b64 v[108:109], v4 offset:1544
    ds_read_b64 v[110:111], v4 offset:1552
    ds_read_b64 v[112:113], v4 offset:3072
    ds_read_b64 v[114:115], v4 offset:3080
    ds_read_b64 v[116:117], v4 offset:3088
    s_branch L_final
L_gather:
    s_mov_b64 s[90:91], -1
    s_mov_b64 s[92:93], -1
    s_mov_b64 s[94:95], -1
    s_mov_b64 s[96:97], -1
    s_mov_b64 s[98:99], -1
    s_mov_b64 s[100:101], 0x00ff00ff
    s_mov_b64 exec, 1
    s_cmp_eq_u32 s40, 5
    s_cselect_b64 vcc, 1, 0
    s_barrier
    s_barrier
    s_barrier
    s_cbranch_vccz L_np2
    buffer_atomic_add v54, v53, s[32:35], s47 offen offset:384 sc0 sc1
L_np2:
    s_barrier
    s_cbranch_vccz L_gate_ok
L_gate:
    v_mov_b32 v55, 0
    buffer_atomic_add v55, v53, s[32:35], s47 offen offset:384 sc0 sc1
    s_waitcnt vmcnt(1)
    v_cmp_eq_u32 vcc, 40, v54
    s_cbranch_vccnz L_gate_ok
    v_mov_b32 v54, 0
    buffer_atomic_add v54, v53, s[32:35], s47 offen offset:384 sc0 sc1
    s_waitcnt vmcnt(1)
    v_cmp_eq_u32 vcc, 40, v55
    s_cbranch_vccnz L_gate_ok
    s_add_u32 s80, s80, 256
    s_cmp_gt_u32 s80, 100000000
    s_cbranch_scc1 L_end
    s_branch L_gate
L_gate_ok:
    s_barrier
    s_mov_b64 exec, s[90:91]
    s_cbranch_execz L_g_f0
    buffer_load_dwordx4 v[16:19], v6, s[32:35], s82 offen sc1
L_g_f0:
    s_mov_b64 exec, s[92:93]
    s_cbranch_execz L_g_f1
    buffer_load_dwordx4 v[20:23], v6, s[32:35], s83 offen sc1
L_g_f1:
    s_mov_b64 exec, s[94:95]
    s_cbranch_execz L_g_f2
    buffer_load_dwordx4 v[24:27], v6, s[32:35], s84 offen sc1
L_g_f2:
    s_mov_b64 exec, s[96:97]
    s_cbranch_execz L_g_f3
    buffer_load_dwordx4 v[28:31], v6, s[32:35], s85 offen sc1
L_g_f3:
    s_mov_b64 exec, s[98:99]
    s_cbranch_execz L_g_f4
    buffer_load_dwordx4 v[32:35], v6, s[32:35], s86 offen sc1
L_g_f4:
    s_mov_b64 exec, s[100:101]
    s_cbranch_execz L_g_f5
    buffer_load_dwordx4 v[36:39], v6, s[32:35], s87 offen sc1
L_g_f5:
    s_mov_b64 exec, -1
    s_and_b32 s80, s80, 0xff
    s_barrier
    ds_read_b64 v[100:101], v4 offset:0
    ds_read_b64 v[102:103], v4 offset:8
    ds_read_b64 v[104:105], v4 offset:16
    ds_read_b64 v[106:107], v4 offset:1536
    ds_read_b64 v[108:109], v4 offset:1544
    ds_read_b64 v[110:111], v4 offset:1552
    ds_read_b64 v[112:113], v4 offset:3072
    ds_read_b64 v[114:115], v4 offset:3080
    ds_read_b64 v[116:117], v4 offset:3088
    s_waitcnt vmcnt(6)
    v_lshlrev_b32 v46, 16, v46
    v_lshlrev_b32 v47, 16, v47
    v_lshlrev_b32 v48, 16, v48
    s_branch L_g_first
L_g_poll:
    s_mov_b64 exec, s[90:91]
    s_cbranch_execz L_g_a0
    buffer_load_dwordx4 v[16:19], v6, s[32:35], s82 offen sc1
L_g_a0:
    s_mov_b64 exec, s[92:93]
    s_cbranch_execz L_g_a1
    buffer_load_dwordx4 v[20:23], v6, s[32:35], s83 offen sc1
L_g_a1:
    s_mov_b64 exec, s[94:95]
    s_cbranch_execz L_g_a2
    buffer_load_dwordx4 v[24:27], v6, s[32:35], s84 offen sc1
L_g_a2:
    s_mov_b64 exec, s[96:97]
    s_cbranch_execz L_g_a3
    buffer_load_dwordx4 v[28:31], v6, s[32:35], s85 offen sc1
L_g_a3:
    s_mov_b64 exec, s[98:99]
    s_cbranch_execz L_g_a4
    buffer_load_dwordx4 v[32:35], v6, s[32:35], s86 offen sc1
L_g_a4:
    s_mov_b64 exec, s[100:101]
    s_cbranch_execz L_g_a5
    buffer_load_dwordx4 v[36:39], v6, s[32:35], s87 offen sc1
L_g_a5:
    s_add_u32 s80, s80, 1
    s_cmp_gt_u32 s80, 400000
    s_cbranch_scc1 L_end
L_g_exact:
    s_waitcnt vmcnt(0)
    s_mov_b64 exec, s[90:91]
    v_max3_u32 v10, v16, v17, v18
    v_max_u32 v10, v10, v19
    v_cmp_eq_u32 s[90:91], -1, v10
    s_mov_b64 exec, s[92:93]
    v_max3_u32 v10, v20, v21, v22
    v_max_u32 v10, v10, v23
    v_cmp_eq_u32 s[92:93], -1, v10
    s_mov_b64 exec, s[94:95]
    v_max3_u32 v10, v24, v25, v26
    v_max_u32 v10, v10, v27
    v_cmp_eq_u32 s[94:95], -1, v10
    s_mov_b64 exec, s[96:97]
    v_max3_u32 v10, v28, v29, v30
    v_max_u32 v10, v10, v31
    v_cmp_eq_u32 s[96:97], -1, v10
    s_mov_b64 exec, s[98:99]
    v_max3_u32 v10, v32, v33, v34
    v_max_u32 v10, v10, v35
    v_cmp_eq_u32 s[98:99], -1, v10
    s_mov_b64 exec, s[100:101]
    v_max3_u32 v10, v36, v37, v38
    v_max_u32 v10, v10, v39
    v_cmp_eq_u32 s[100:101], -1, v10
    s_or_b64 vcc, s[90:91], s[92:93]
    s_or_b64 vcc, vcc, s[94:95]
    s_or_b64 vcc, vcc, s[96:97]
    s_or_b64 vcc, vcc, s[98:99]
    s_or_b64 vcc, vcc, s[100:101]
    s_cbranch_scc1 L_g_poll
    s_mov_b64 exec, -1
    v_add_f32 v40, v16, v20
    v_add_f32 v42, v18, v22
    v_add_f32 v41, v17, v21
    v_add_f32 v43, v19, v23
    v_add_f32 v40, v40, v24
    v_add_f32 v42, v42, v26
    v_add_f32 v41, v41, v25
    v_add_f32 v43, v43, v27
    v_add_f32 v40, v40, v28
    v_add_f32 v42, v42, v30
    v_add_f32 v41, v41, v29
    v_add_f32 v43, v43, v31
    v_add_f32 v40, v40, v32
    v_add_f32 v42, v42, v34
    v_add_f32 v41, v41, v33
    v_add_f32 v43, v43, v35
    v_add_f32 v40, v40, v36
    v_add_f32 v42, v42, v38
    v_add_f32 v41, v41, v37
    v_add_f32 v43, v43, v39
    s_branch L_g_done
L_g_first:
    s_waitcnt vmcnt(4)
    v_add_f32 v40, v16, v20
    v_add_f32 v42, v18, v22
    v_add_f32 v41, v17, v21
    v_add_f32 v43, v19, v23
    s_waitcnt vmcnt(3)
    v_add_f32 v40, v40, v24
    v_add_f32 v42, v42, v26
    v_add_f32 v41, v41, v25
    v_add_f32 v43, v43, v27
    s_waitcnt vmcnt(2)
    v_add_f32 v40, v40, v28
    v_add_f32 v42, v42, v30
    v_add_f32 v41, v41, v29
    v_add_f32 v43, v43, v31
    s_waitcnt vmcnt(1)
    v_add_f32 v40, v40, v32
    v_add_f32 v42, v42, v34
    v_add_f32 v41, v41, v33
    v_add_f32 v43, v43, v35
    s_waitcnt vmcnt(0)
    v_add_f32 v40, v40, v36
    v_add_f32 v42, v42, v38
    v_add_f32 v41, v41, v37
    v_add_f32 v43, v43, v39
    v_cmp_u_f32 vcc, v40, v42
    v_cmp_u_f32 s[54:55], v41, v43
    s_or_b64 vcc, vcc, s[54:55]
    s_cbranch_scc1 L_g_exact
L_g_done:
    v_permlane32_swap_b32 v40, v42
    s_nop 0
    v_permlane32_swap_b32 v41, v43
    v_add_f32 v16, v40, v42
    v_add_f32 v17, v41, v43
    s_nop 0
    v_add_f32_dpp v16, v16, v16 row_ror:4 row_mask:0xf bank_mask:0xf
    v_add_f32_dpp v17, v17, v17 row_ror:4 row_mask:0xf bank_mask:0xf
    s_nop 0
    v_add_f32_dpp v16, v16, v16 row_ror:8 row_mask:0xf bank_mask:0xf
    v_add_f32_dpp v17, v17, v17 row_ror:8 row_mask:0xf bank_mask:0xf
    v_mul_f32 v16, 0x39035177, v16
    v_mul_f32 v17, 0x39035177, v17
    v_fma_f32 v17, -v16, v16, v17
    v_max_f32 v17, 0, v17
    v_add_f32 v17, 0x3727c5ac, v17
    v_rsq_f32 v17, v17
    v_add_f32 v16, v16, v46
    v_sub_f32 v16, v46, v16
    s_mov_b32 exec_lo, 0x000f000f
    s_mov_b32 exec_hi, 0x000f000f
    v_mul_f32 v20, v47, v17
    v_fma_f32 v21, v16, v20, v48
    ds_write2_b32 v7, v20, v21 offset1:6
    s_mov_b64 exec, -1
    s_branch L_final
.p2align 12
L_s_x:
L_pad_l0:
    s_cbranch_scc1 L_ret
    s_barrier
    s_barrier
    s_mov_b32 m0, 26880
    s_movk_i32 s50, 640
    buffer_load_dwordx4 v1, s[20:23], s50 offen lds
    s_addk_i32 m0, 1024
    s_addk_i32 s50, 9216
    buffer_load_dwordx4 v1, s[20:23], s50 offen lds
    s_addk_i32 m0, 1024
    s_addk_i32 s50, 9216
    buffer_load_dwordx4 v1, s[20:23], s50 offen lds
    s_addk_i32 m0, 1024
    s_addk_i32 s50, 9216
    buffer_load_dwordx4 v1, s[20:23], s50 offen lds
    s_addk_i32 m0, 1024
    s_addk_i32 s50, 9216
    buffer_load_dwordx4 v1, s[20:23], s50 offen lds
    s_addk_i32 m0, 1024
    s_addk_i32 s50, 9216
    buffer_load_dwordx4 v1, s[20:23], s50 offen lds
    s_addk_i32 m0, 1024
    s_addk_i32 s50, 9216
    buffer_load_dwordx4 v1, s[20:23], s50 offen lds
    s_addk_i32 m0, 1024
    s_addk_i32 s50, 9216
    buffer_load_dwordx4 v1, s[20:23], s50 offen lds
    s_addk_i32 m0, 1024
    s_addk_i32 s50, 9216
    buffer_load_dwordx4 v1, s[20:23], s50 offen lds
    s_addk_i32 m0, 1024
    s_addk_i32 s50, 9216
    buffer_load_dwordx4 v1, s[20:23], s50 offen lds
    s_addk_i32 m0, 1024
    s_addk_i32 s50, 9216
    buffer_load_dwordx4 v1, s[20:23], s50 offen lds
    s_addk_i32 m0, 1024
    s_addk_i32 s50, 9216
    buffer_load_dwordx4 v1, s[20:23], s50 offen lds
    s_addk_i32 m0, 1024
    s_addk_i32 s50, 9216
    buffer_load_dwordx4 v1, s[20:23], s50 offen lds
    s_barrier
    s_barrier
    s_barrier
    s_barrier
    s_cmp_eq_u32 0, 0
    s_call_b64 s[78:79], L_pad_m1
    s_cmp_eq_u32 0, 1
    s_barrier
    s_barrier
    s_waitcnt vmcnt(0)
    s_barrier
    s_mov_b32 m0, 40192
    s_movk_i32 s50, 128
    buffer_load_dwordx4 v1, s[20:23], s50 offen lds
    s_addk_i32 m0, 1024
    s_addk_i32 s50, 9216
    buffer_load_dwordx4 v1, s[20:23], s50 offen lds
    s_addk_i32 m0, 1024
    s_addk_i32 s50, 9216
    buffer_load_dwordx4 v1, s[20:23], s50 offen lds
    s_addk_i32 m0, 1024
    s_addk_i32 s50, 9216
    buffer_load_dwordx4 v1, s[20:23], s50 offen lds
    s_addk_i32 m0, 1024
    s_addk_i32 s50, 9216
    buffer_load_dwordx4 v1, s[20:23], s50 offen lds
    s_addk_i32 m0, 1024
    s_addk_i32 s50, 9216
    buffer_load_dwordx4 v1, s[20:23], s50 offen lds
    s_addk_i32 m0, 1024
    s_addk_i32 s50, 9216
    buffer_load_dwordx4 v1, s[20:23], s50 offen lds
    s_addk_i32 m0, 1024
    s_addk_i32 s50, 9216
    buffer_load_dwordx4 v1, s[20:23], s50 offen lds
    s_addk_i32 m0, 1024
    s_addk_i32 s50, 9216
    buffer_load_dwordx4 v1, s[20:23], s50 offen lds
    s_addk_i32 m0, 1024
    s_addk_i32 s50, 9216
    buffer_load_dwordx4 v1, s[20:23], s50 offen lds
    s_addk_i32 m0, 1024
    s_addk_i32 s50, 9216
    buffer_load_dwordx4 v1, s[20:23], s50 offen lds
    s_addk_i32 m0, 1024
    s_addk_i32 s50, 9216
    buffer_load_dwordx4 v1, s[20:23], s50 offen lds
    s_addk_i32 m0, 1024
    s_addk_i32 s50, 9216
    buffer_load_dwordx4 v1, s[20:23], s50 offen lds
    s_barrier
    s_barrier
    s_barrier
    s_barrier
    s_cmp_eq_u32 0, 0
    s_call_b64 s[78:79], L_pad_m2
    s_cmp_eq_u32 0, 1
    s_barrier
    s_cmp_eq_u32 0, 0
    s_call_b64 s[78:79], L_pad_l1
    s_cmp_eq_u32 0, 1
    s_barrier
    s_cmp_eq_u32 0, 0
    s_call_b64 s[78:79], L_pad_k1
    s_cmp_eq_u32 0, 1
    s_barrier
    s_waitcnt vmcnt(0)
    s_barrier
    buffer_load_dword v10, v11, s[36:39], 0 offen offset:0 sc1
    s_mov_b32 m0, 256
    s_movk_i32 s50, 768
    buffer_load_dwordx4 v1, s[20:23], s50 offen lds
    s_addk_i32 m0, 1024
    s_addk_i32 s50, 9216
    buffer_load_dwordx4 v1, s[20:23], s50 offen lds
    s_addk_i32 m0, 1024
    s_addk_i32 s50, 9216
    buffer_load_dwordx4 v1, s[20:23], s50 offen lds
    s_addk_i32 m0, 1024
    s_addk_i32 s50, 9216
    buffer_load_dwordx4 v1, s[20:23], s50 offen lds
    s_addk_i32 m0, 1024
    s_addk_i32 s50, 9216
    buffer_load_dwordx4 v1, s[20:23], s50 offen lds
    s_addk_i32 m0, 1024
    s_addk_i32 s50, 9216
    buffer_load_dwordx4 v1, s[20:23], s50 offen lds
    s_addk_i32 m0, 1024
    s_addk_i32 s50, 9216
    buffer_load_dwordx4 v1, s[20:23], s50 offen lds
    s_addk_i32 m0, 1024
    s_addk_i32 s50, 9216
    buffer_load_dwordx4 v1, s[20:23], s50 offen lds
    s_addk_i32 m0, 1024
    s_addk_i32 s50, 9216
    buffer_load_dwordx4 v1, s[20:23], s50 offen lds
    s_addk_i32 m0, 1024
    s_addk_i32 s50, 9216
    buffer_load_dwordx4 v1, s[20:23], s50 offen lds
    s_addk_i32 m0, 1024
    s_addk_i32 s50, 9216
    buffer_load_dwordx4 v1, s[20:23], s50 offen lds
    s_addk_i32 m0, 1024
    s_addk_i32 s50, 9216
    buffer_load_dwordx4 v1, s[20:23], s50 offen lds
    s_addk_i32 m0, 1024
    s_addk_i32 s50, 9216
    buffer_load_dwordx4 v1, s[20:23], s50 offen lds
    s_barrier
    s_barrier
    s_barrier
    s_waitcnt vmcnt(13)
L_ck20:
    v_cmp_eq_u32 vcc, 0, v10
    s_cbranch_vccz L_ck20_ok
    s_add_u32 s80, s80, 1
    s_cmp_gt_u32 s80, 400000
    s_cbranch_scc1 L_end
    buffer_load_dword v10, v11, s[36:39], 0 offen offset:0 sc1
    s_waitcnt vmcnt(0)
    s_branch L_ck20
L_ck20_ok:
    s_barrier
    s_cmp_eq_u32 0, 0
    s_call_b64 s[78:79], L_pad_m4
    s_cmp_eq_u32 0, 1
    s_barrier
    s_cmp_eq_u32 0, 0
    s_call_b64 s[78:79], L_pad_m3
    s_cmp_eq_u32 0, 1
    s_barrier
    s_mov_b32 m0, 13568
    s_movk_i32 s50, 256
    buffer_load_dwordx4 v1, s[20:23], s50 offen lds
    s_addk_i32 m0, 1024
    s_addk_i32 s50, 9216
    buffer_load_dwordx4 v1, s[20:23], s50 offen lds
    s_addk_i32 m0, 1024
    s_addk_i32 s50, 9216
    buffer_load_dwordx4 v1, s[20:23], s50 offen lds
    s_barrier
    s_addk_i32 m0, 1024
    s_addk_i32 s50, 9216
    buffer_load_dwordx4 v1, s[20:23], s50 offen lds
    s_addk_i32 m0, 1024
    s_addk_i32 s50, 9216
    buffer_load_dwordx4 v1, s[20:23], s50 offen lds
    s_waitcnt vmcnt(5)
    s_barrier
    buffer_load_dword v10, v11, s[36:39], 0 offen offset:128 sc1
    s_addk_i32 m0, 1024
    s_addk_i32 s50, 9216
    buffer_load_dwordx4 v1, s[20:23], s50 offen lds
    s_addk_i32 m0, 1024
    s_addk_i32 s50, 9216
    buffer_load_dwordx4 v1, s[20:23], s50 offen lds
    s_barrier
    s_addk_i32 m0, 1024
    s_addk_i32 s50, 9216
    buffer_load_dwordx4 v1, s[20:23], s50 offen lds
    s_addk_i32 m0, 1024
    s_addk_i32 s50, 9216
    buffer_load_dwordx4 v1, s[20:23], s50 offen lds
    s_barrier
    s_addk_i32 m0, 1024
    s_addk_i32 s50, 9216
    buffer_load_dwordx4 v1, s[20:23], s50 offen lds
    s_addk_i32 m0, 1024
    s_addk_i32 s50, 9216
    buffer_load_dwordx4 v1, s[20:23], s50 offen lds
    s_barrier
    s_addk_i32 m0, 1024
    s_addk_i32 s50, 9216
    buffer_load_dwordx4 v1, s[20:23], s50 offen lds
    s_addk_i32 m0, 1024
    s_addk_i32 s50, 9216
    buffer_load_dwordx4 v1, s[20:23], s50 offen lds
    s_waitcnt vmcnt(8)
L_ck28:
    v_cmp_eq_u32 vcc, 0, v10
    s_cbranch_vccz L_ck28_ok
    s_add_u32 s80, s80, 1
    s_cmp_gt_u32 s80, 400000
    s_cbranch_scc1 L_end
    buffer_load_dword v10, v11, s[36:39], 0 offen offset:128 sc1
    s_waitcnt vmcnt(0)
    s_branch L_ck28
L_ck28_ok:
    s_barrier
    s_cmp_eq_u32 0, 0
    s_call_b64 s[78:79], L_pad_m5
    s_cmp_eq_u32 0, 1
    s_barrier
    s_cmp_eq_u32 0, 0
    s_call_b64 s[78:79], L_pad_f
    s_cmp_eq_u32 0, 1
    s_barrier
    s_mov_b32 m0, 26880
    s_movk_i32 s50, 896
    buffer_load_dwordx4 v1, s[20:23], s50 offen lds
    s_addk_i32 m0, 1024
    s_addk_i32 s50, 9216
    buffer_load_dwordx4 v1, s[20:23], s50 offen lds
    s_addk_i32 m0, 1024
    s_addk_i32 s50, 9216
    buffer_load_dwordx4 v1, s[20:23], s50 offen lds
    s_barrier
    buffer_load_dword v10, v11, s[36:39], 0 offen offset:16 sc1
    s_addk_i32 m0, 1024
    s_addk_i32 s50, 9216
    buffer_load_dwordx4 v1, s[20:23], s50 offen lds
    s_addk_i32 m0, 1024
    s_addk_i32 s50, 9216
    buffer_load_dwordx4 v1, s[20:23], s50 offen lds
    s_waitcnt vmcnt(6)
    s_barrier
    s_addk_i32 m0, 1024
    s_addk_i32 s50, 9216
    buffer_load_dwordx4 v1, s[20:23], s50 offen lds
    s_addk_i32 m0, 1024
    s_addk_i32 s50, 9216
    buffer_load_dwordx4 v1, s[20:23], s50 offen lds
    s_barrier
    s_addk_i32 m0, 1024
    s_addk_i32 s50, 9216
    buffer_load_dwordx4 v1, s[20:23], s50 offen lds
    s_addk_i32 m0, 1024
    s_addk_i32 s50, 9216
    buffer_load_dwordx4 v1, s[20:23], s50 offen lds
    s_barrier
    s_addk_i32 m0, 1024
    s_addk_i32 s50, 9216
    buffer_load_dwordx4 v1, s[20:23], s50 offen lds
    s_addk_i32 m0, 1024
    s_addk_i32 s50, 9216
    buffer_load_dwordx4 v1, s[20:23], s50 offen lds
    s_waitcnt vmcnt(8)
L_ck35:
    v_cmp_eq_u32 vcc, 0, v10
    s_cbranch_vccz L_ck35_ok
    s_add_u32 s80, s80, 1
    s_cmp_gt_u32 s80, 400000
    s_cbranch_scc1 L_end
    buffer_load_dword v10, v11, s[36:39], 0 offen offset:16 sc1
    s_waitcnt vmcnt(0)
    s_branch L_ck35
L_ck35_ok:
    s_barrier
    s_addk_i32 m0, 1024
    s_addk_i32 s50, 9216
    buffer_load_dwordx4 v1, s[20:23], s50 offen lds
    s_addk_i32 m0, 1024
    s_addk_i32 s50, 9216
    buffer_load_dwordx4 v1, s[20:23], s50 offen lds
    s_barrier
    s_barrier
    s_mov_b32 m0, 40192
    s_movk_i32 s50, 384
    buffer_load_dwordx4 v1, s[20:23], s50 offen lds
    s_addk_i32 m0, 1024
    s_addk_i32 s50, 9216
    buffer_load_dwordx4 v1, s[20:23], s50 offen lds
    s_addk_i32 m0, 1024
    s_addk_i32 s50, 9216
    buffer_load_dwordx4 v1, s[20:23], s50 offen lds
    s_barrier
    buffer_load_dword v10, v11, s[36:39], 0 offen offset:144 sc1
    s_addk_i32 m0, 1024
    s_addk_i32 s50, 9216
    buffer_load_dwordx4 v1, s[20:23], s50 offen lds
    s_addk_i32 m0, 1024
    s_addk_i32 s50, 9216
    buffer_load_dwordx4 v1, s[20:23], s50 offen lds
    s_barrier
    s_addk_i32 m0, 1024
    s_addk_i32 s50, 9216
    buffer_load_dwordx4 v1, s[20:23], s50 offen lds
    s_addk_i32 m0, 1024
    s_addk_i32 s50, 9216
    buffer_load_dwordx4 v1, s[20:23], s50 offen lds
    s_waitcnt vmcnt(8)
    s_barrier
    s_addk_i32 m0, 1024
    s_addk_i32 s50, 9216
    buffer_load_dwordx4 v1, s[20:23], s50 offen lds
    s_addk_i32 m0, 1024
    s_addk_i32 s50, 9216
    buffer_load_dwordx4 v1, s[20:23], s50 offen lds
    s_barrier
    s_addk_i32 m0, 1024
    s_addk_i32 s50, 9216
    buffer_load_dwordx4 v1, s[20:23], s50 offen lds
    s_addk_i32 m0, 1024
    s_addk_i32 s50, 9216
    buffer_load_dwordx4 v1, s[20:23], s50 offen lds
    s_waitcnt vmcnt(8)
L_ck42:
    v_cmp_eq_u32 vcc, 0, v10
    s_cbranch_vccz L_ck42_ok
    s_add_u32 s80, s80, 1
    s_cmp_gt_u32 s80, 400000
    s_cbranch_scc1 L_end
    buffer_load_dword v10, v11, s[36:39], 0 offen offset:144 sc1
    s_waitcnt vmcnt(0)
    s_branch L_ck42
L_ck42_ok:
    s_barrier
    s_addk_i32 m0, 1024
    s_addk_i32 s50, 9216
    buffer_load_dwordx4 v1, s[20:23], s50 offen lds
    s_addk_i32 m0, 1024
    s_addk_i32 s50, 9216
    buffer_load_dwordx4 v1, s[20:23], s50 offen lds
    s_barrier
    s_barrier
    s_barrier
    s_mov_b32 m0, 256
    s_movk_i32 s50, 1024
    buffer_load_dwordx4 v1, s[20:23], s50 offen lds
    s_addk_i32 m0, 1024
    s_addk_i32 s50, 9216
    buffer_load_dwordx4 v1, s[20:23], s50 offen lds
    s_addk_i32 m0, 1024
    s_addk_i32 s50, 9216
    buffer_load_dwordx4 v1, s[20:23], s50 offen lds
    s_barrier
    buffer_load_dword v10, v11, s[36:39], 0 offen offset:32 sc1
    s_addk_i32 m0, 1024
    s_addk_i32 s50, 9216
    buffer_load_dwordx4 v1, s[20:23], s50 offen lds
    s_addk_i32 m0, 1024
    s_addk_i32 s50, 9216
    buffer_load_dwordx4 v1, s[20:23], s50 offen lds
    s_waitcnt vmcnt(6)
    s_barrier
    s_addk_i32 m0, 1024
    s_addk_i32 s50, 9216
    buffer_load_dwordx4 v1, s[20:23], s50 offen lds
    s_addk_i32 m0, 1024
    s_addk_i32 s50, 9216
    buffer_load_dwordx4 v1, s[20:23], s50 offen lds
    s_barrier
    s_addk_i32 m0, 1024
    s_addk_i32 s50, 9216
    buffer_load_dwordx4 v1, s[20:23], s50 offen lds
    s_addk_i32 m0, 1024
    s_addk_i32 s50, 9216
    buffer_load_dwordx4 v1, s[20:23], s50 offen lds
    s_barrier
    s_addk_i32 m0, 1024
    s_addk_i32 s50, 9216
    buffer_load_dwordx4 v1, s[20:23], s50 offen lds
    s_addk_i32 m0, 1024
    s_addk_i32 s50, 9216
    buffer_load_dwordx4 v1, s[20:23], s50 offen lds
    s_waitcnt vmcnt(8)
L_ck50:
    v_cmp_eq_u32 vcc, 0, v10
    s_cbranch_vccz L_ck50_ok
    s_add_u32 s80, s80, 1
    s_cmp_gt_u32 s80, 400000
    s_cbranch_scc1 L_end
    buffer_load_dword v10, v11, s[36:39], 0 offen offset:32 sc1
    s_waitcnt vmcnt(0)
    s_branch L_ck50
L_ck50_ok:
    s_barrier
    s_addk_i32 m0, 1024
    s_addk_i32 s50, 9216
    buffer_load_dwordx4 v1, s[20:23], s50 offen lds
    s_addk_i32 m0, 1024
    s_addk_i32 s50, 9216
    buffer_load_dwordx4 v1, s[20:23], s50 offen lds
    s_barrier
    s_barrier
    s_mov_b32 m0, 13568
    s_movk_i32 s50, 512
    buffer_load_dwordx4 v1, s[20:23], s50 offen lds
    s_addk_i32 m0, 1024
    s_addk_i32 s50, 9216
    buffer_load_dwordx4 v1, s[20:23], s50 offen lds
    s_addk_i32 m0, 1024
    s_addk_i32 s50, 9216
    buffer_load_dwordx4 v1, s[20:23], s50 offen lds
    s_barrier
    buffer_load_dword v10, v11, s[36:39], 0 offen offset:160 sc1
    s_addk_i32 m0, 1024
    s_addk_i32 s50, 9216
    buffer_load_dwordx4 v1, s[20:23], s50 offen lds
    s_addk_i32 m0, 1024
    s_addk_i32 s50, 9216
    buffer_load_dwordx4 v1, s[20:23], s50 offen lds
    s_barrier
    s_addk_i32 m0, 1024
    s_addk_i32 s50, 9216
    buffer_load_dwordx4 v1, s[20:23], s50 offen lds
    s_addk_i32 m0, 1024
    s_addk_i32 s50, 9216
    buffer_load_dwordx4 v1, s[20:23], s50 offen lds
    s_waitcnt vmcnt(8)
    s_barrier
    s_addk_i32 m0, 1024
    s_addk_i32 s50, 9216
    buffer_load_dwordx4 v1, s[20:23], s50 offen lds
    s_addk_i32 m0, 1024
    s_addk_i32 s50, 9216
    buffer_load_dwordx4 v1, s[20:23], s50 offen lds
    s_barrier
    s_addk_i32 m0, 1024
    s_addk_i32 s50, 9216
    buffer_load_dwordx4 v1, s[20:23], s50 offen lds
    s_addk_i32 m0, 1024
    s_addk_i32 s50, 9216
    buffer_load_dwordx4 v1, s[20:23], s50 offen lds
    s_waitcnt vmcnt(8)
L_ck57:
    v_cmp_eq_u32 vcc, 0, v10
    s_cbranch_vccz L_ck57_ok
    s_add_u32 s80, s80, 1
    s_cmp_gt_u32 s80, 400000
    s_cbranch_scc1 L_end
    buffer_load_dword v10, v11, s[36:39], 0 offen offset:160 sc1
    s_waitcnt vmcnt(0)
    s_branch L_ck57
L_ck57_ok:
    s_barrier
    s_addk_i32 m0, 1024
    s_addk_i32 s50, 9216
    buffer_load_dwordx4 v1, s[20:23], s50 offen lds
    s_addk_i32 m0, 1024
    s_addk_i32 s50, 9216
    buffer_load_dwordx4 v1, s[20:23], s50 offen lds
    s_barrier
    s_barrier
    s_barrier
    s_barrier
    s_waitcnt vmcnt(0)
    s_barrier
    s_barrier
    s_barrier
    s_barrier
    s_branch L_publish
L_s_w:
    s_waitcnt vmcnt(8)
    s_barrier
    s_addk_i32 m0, 3072
    s_mov_b32 s50, 414720
    buffer_load_dwordx4 v2, s[24:27], s50 offen lds
    s_addk_i32 m0, 3072
    s_mov_b32 s50, 1078272
    buffer_load_dwordx4 v2, s[24:27], s50 offen lds
    s_waitcnt vmcnt(8)
    s_barrier
    s_addk_i32 m0, 3072
    s_mov_b32 s50, 497664
    buffer_load_dwordx4 v2, s[24:27], s50 offen lds
    s_waitcnt vmcnt(5)
    s_barrier
    s_addk_i32 m0, 3072
    s_mov_b32 s50, 1161216
    buffer_load_dwordx4 v2, s[24:27], s50 offen lds
    s_addk_i32 m0, 3072
    s_mov_b32 s50, 580608
    buffer_load_dwordx4 v2, s[24:27], s50 offen lds
    s_barrier
    s_addk_i32 m0, 3072
    s_mov_b32 s50, 1244160
    buffer_load_dwordx4 v2, s[24:27], s50 offen lds
    s_addk_i32 m0, 3072
    s_mov_b32 s50, 9216
    buffer_load_dwordx4 v2, s[24:27], s50 offen lds
    s_waitcnt vmcnt(5)
    s_barrier
    s_addk_i32 m0, 3072
    s_mov_b32 s50, 672768
    buffer_load_dwordx4 v2, s[24:27], s50 offen lds
    s_addk_i32 m0, 3072
    s_mov_b32 s50, 92160
    buffer_load_dwordx4 v2, s[24:27], s50 offen lds
    s_addk_i32 m0, 3072
    s_mov_b32 s50, 755712
    buffer_load_dwordx4 v2, s[24:27], s50 offen lds
    s_barrier
    s_addk_i32 m0, 3072
    s_mov_b32 s50, 175104
    buffer_load_dwordx4 v2, s[24:27], s50 offen lds
    s_addk_i32 m0, 3072
    s_mov_b32 s50, 838656
    buffer_load_dwordx4 v2, s[24:27], s50 offen lds
    s_mov_b32 m0, s51
    s_mov_b32 s50, 258048
    buffer_load_dwordx4 v2, s[24:27], s50 offen lds
    s_waitcnt vmcnt(7)
    s_barrier
    s_addk_i32 m0, 3072
    s_mov_b32 s50, 921600
    buffer_load_dwordx4 v2, s[24:27], s50 offen lds
    s_addk_i32 m0, 3072
    s_mov_b32 s50, 340992
    buffer_load_dwordx4 v2, s[24:27], s50 offen lds
    s_barrier
    s_addk_i32 m0, 3072
    s_mov_b32 s50, 1004544
    buffer_load_dwordx4 v2, s[24:27], s50 offen lds
    s_addk_i32 m0, 3072
    s_mov_b32 s50, 423936
    buffer_load_dwordx4 v2, s[24:27], s50 offen lds
    s_addk_i32 m0, 3072
    s_mov_b32 s50, 1087488
    buffer_load_dwordx4 v2, s[24:27], s50 offen lds
    s_waitcnt vmcnt(8)
    s_barrier
    s_barrier
    s_addk_i32 m0, 3072
    s_mov_b32 s50, 506880
    buffer_load_dwordx4 v2, s[24:27], s50 offen lds
    s_addk_i32 m0, 3072
    s_mov_b32 s50, 1170432
    buffer_load_dwordx4 v2, s[24:27], s50 offen lds
    s_waitcnt vmcnt(6)
    s_barrier
    s_addk_i32 m0, 3072
    s_mov_b32 s50, 589824
    buffer_load_dwordx4 v2, s[24:27], s50 offen lds
    s_addk_i32 m0, 3072
    s_mov_b32 s50, 1253376
    buffer_load_dwordx4 v2, s[24:27], s50 offen lds
    s_barrier
    s_addk_i32 m0, 3072
    s_mov_b32 s50, 18432
    buffer_load_dwordx4 v2, s[24:27], s50 offen lds
    s_addk_i32 m0, 3072
    s_mov_b32 s50, 681984
    buffer_load_dwordx4 v2, s[24:27], s50 offen lds
    s_addk_i32 m0, 3072
    s_mov_b32 s50, 101376
    buffer_load_dwordx4 v2, s[24:27], s50 offen lds
    s_waitcnt vmcnt(7)
    s_barrier
    s_addk_i32 m0, 3072
    s_mov_b32 s50, 764928
    buffer_load_dwordx4 v2, s[24:27], s50 offen lds
    s_addk_i32 m0, 3072
    s_mov_b32 s50, 184320
    buffer_load_dwordx4 v2, s[24:27], s50 offen lds
    s_addk_i32 m0, 3072
    s_mov_b32 s50, 847872
    buffer_load_dwordx4 v2, s[24:27], s50 offen lds
    s_barrier
    s_addk_i32 m0, 3072
    s_mov_b32 s50, 267264
    buffer_load_dwordx4 v2, s[24:27], s50 offen lds
    s_addk_i32 m0, 3072
    s_mov_b32 s50, 930816
    buffer_load_dwordx4 v2, s[24:27], s50 offen lds
    s_waitcnt vmcnt(8)
    s_barrier
    s_addk_i32 m0, 3072
    s_mov_b32 s50, 350208
    buffer_load_dwordx4 v2, s[24:27], s50 offen lds
    s_addk_i32 m0, 3072
    s_mov_b32 s50, 1013760
    buffer_load_dwordx4 v2, s[24:27], s50 offen lds
    s_addk_i32 m0, 3072
    s_mov_b32 s50, 433152
    buffer_load_dwordx4 v2, s[24:27], s50 offen lds
    s_barrier
    s_addk_i32 m0, 3072
    s_mov_b32 s50, 1096704
    buffer_load_dwordx4 v2, s[24:27], s50 offen lds
    s_mov_b32 m0, s51
    s_mov_b32 s50, 516096
    buffer_load_dwordx4 v2, s[24:27], s50 offen lds
    s_addk_i32 m0, 3072
    s_mov_b32 s50, 1179648
    buffer_load_dwordx4 v2, s[24:27], s50 offen lds
    s_waitcnt vmcnt(10)
    s_barrier
    s_barrier
    s_addk_i32 m0, 3072
    s_mov_b32 s50, 599040
    buffer_load_dwordx4 v2, s[24:27], s50 offen lds
    s_addk_i32 m0, 3072
    s_mov_b32 s50, 1262592
    buffer_load_dwordx4 v2, s[24:27], s50 offen lds
    s_waitcnt vmcnt(8)
    s_barrier
    s_barrier
    s_waitcnt vmcnt(4)
    s_barrier
    s_addk_i32 m0, 3072
    s_mov_b32 s52, 147456
    buffer_load_dwordx4 v12, s[56:59], s52 offen sc1 lds
    s_addk_i32 m0, 3072
    s_mov_b32 s53, 172032
    buffer_load_dwordx4 v12, s[56:59], s53 offen sc1 lds
    s_addk_i32 m0, 3072
    s_addk_i32 s52, 3072
    buffer_load_dwordx4 v12, s[56:59], s52 offen sc1 lds
    s_addk_i32 m0, 3072
    s_addk_i32 s53, 3072
    buffer_load_dwordx4 v12, s[56:59], s53 offen sc1 lds
    s_barrier
    s_addk_i32 m0, 3072
    s_addk_i32 s52, 3072
    buffer_load_dwordx4 v12, s[56:59], s52 offen sc1 lds
    s_addk_i32 m0, 3072
    s_addk_i32 s53, 3072
    buffer_load_dwordx4 v12, s[56:59], s53 offen sc1 lds
    s_addk_i32 m0, 3072
    s_addk_i32 s52, 3072
    buffer_load_dwordx4 v12, s[56:59], s52 offen sc1 lds
    s_addk_i32 m0, 3072
    s_addk_i32 s53, 3072
    buffer_load_dwordx4 v12, s[56:59], s53 offen sc1 lds
    s_waitcnt vmcnt(8)
    s_barrier
    s_addk_i32 m0, 3072
    s_addk_i32 s52, 3072
    buffer_load_dwordx4 v12, s[56:59], s52 offen sc1 lds
    s_addk_i32 m0, 3072
    s_addk_i32 s53, 3072
    buffer_load_dwordx4 v12, s[56:59], s53 offen sc1 lds
    s_addk_i32 m0, 3072
    s_addk_i32 s52, 3072
    buffer_load_dwordx4 v12, s[56:59], s52 offen sc1 lds
    s_addk_i32 m0, 3072
    s_addk_i32 s53, 3072
    buffer_load_dwordx4 v12, s[56:59], s53 offen sc1 lds
    s_barrier
    s_addk_i32 m0, 3072
    s_addk_i32 s52, 3072
    buffer_load_dwordx4 v12, s[56:59], s52 offen sc1 lds
    s_addk_i32 m0, 3072
    s_addk_i32 s53, 3072
    buffer_load_dwordx4 v12, s[56:59], s53 offen sc1 lds
    s_addk_i32 m0, 3072
    s_addk_i32 s52, 3072
    buffer_load_dwordx4 v12, s[56:59], s52 offen sc1 lds
    s_addk_i32 m0, 3072
    s_addk_i32 s53, 3072
    buffer_load_dwordx4 v12, s[56:59], s53 offen sc1 lds
    s_waitcnt vmcnt(12)
    s_barrier
    s_barrier
    s_waitcnt vmcnt(8)
    s_barrier
    s_barrier
    s_waitcnt vmcnt(4)
    s_barrier
    s_addk_i32 m0, 3072
    s_mov_b32 s52, 196608
    buffer_load_dwordx4 v12, s[56:59], s52 offen sc1 lds
    s_addk_i32 m0, 3072
    s_mov_b32 s53, 221184
    buffer_load_dwordx4 v12, s[56:59], s53 offen sc1 lds
    s_mov_b32 m0, s51
    s_addk_i32 s52, 3072
    buffer_load_dwordx4 v12, s[56:59], s52 offen sc1 lds
    s_addk_i32 m0, 3072
    s_addk_i32 s53, 3072
    buffer_load_dwordx4 v12, s[56:59], s53 offen sc1 lds
    s_barrier
    s_addk_i32 m0, 3072
    s_addk_i32 s52, 3072
    buffer_load_dwordx4 v12, s[56:59], s52 offen sc1 lds
    s_addk_i32 m0, 3072
    s_addk_i32 s53, 3072
    buffer_load_dwordx4 v12, s[56:59], s53 offen sc1 lds
    s_addk_i32 m0, 3072
    s_addk_i32 s52, 3072
    buffer_load_dwordx4 v12, s[56:59], s52 offen sc1 lds
    s_addk_i32 m0, 3072
    s_addk_i32 s53, 3072
    buffer_load_dwordx4 v12, s[56:59], s53 offen sc1 lds
    s_waitcnt vmcnt(8)
    s_barrier
    s_addk_i32 m0, 3072
    s_addk_i32 s52, 3072
    buffer_load_dwordx4 v12, s[56:59], s52 offen sc1 lds
    s_addk_i32 m0, 3072
    s_addk_i32 s53, 3072
    buffer_load_dwordx4 v12, s[56:59], s53 offen sc1 lds
    s_addk_i32 m0, 3072
    s_addk_i32 s52, 3072
    buffer_load_dwordx4 v12, s[56:59], s52 offen sc1 lds
    s_addk_i32 m0, 3072
    s_addk_i32 s53, 3072
    buffer_load_dwordx4 v12, s[56:59], s53 offen sc1 lds
    s_barrier
    s_addk_i32 m0, 3072
    s_addk_i32 s52, 3072
    buffer_load_dwordx4 v12, s[56:59], s52 offen sc1 lds
    s_addk_i32 m0, 3072
    s_addk_i32 s53, 3072
    buffer_load_dwordx4 v12, s[56:59], s53 offen sc1 lds
    s_addk_i32 m0, 3072
    s_addk_i32 s52, 3072
    buffer_load_dwordx4 v12, s[56:59], s52 offen sc1 lds
    s_addk_i32 m0, 3072
    s_addk_i32 s53, 3072
    buffer_load_dwordx4 v12, s[56:59], s53 offen sc1 lds
    s_waitcnt vmcnt(12)
    s_barrier
    s_barrier
    s_waitcnt vmcnt(8)
    s_barrier
    s_barrier
    s_addk_i32 m0, 3072
    s_mov_b32 s52, 245760
    buffer_load_dwordx4 v12, s[56:59], s52 offen sc1 lds
    s_addk_i32 m0, 3072
    s_mov_b32 s53, 270336
    buffer_load_dwordx4 v12, s[56:59], s53 offen sc1 lds
    s_addk_i32 m0, 3072
    s_addk_i32 s52, 3072
    buffer_load_dwordx4 v12, s[56:59], s52 offen sc1 lds
    s_addk_i32 m0, 3072
    s_addk_i32 s53, 3072
    buffer_load_dwordx4 v12, s[56:59], s53 offen sc1 lds
    s_waitcnt vmcnt(8)
    s_barrier
    s_addk_i32 m0, 3072
    s_addk_i32 s52, 3072
    buffer_load_dwordx4 v12, s[56:59], s52 offen sc1 lds
    s_addk_i32 m0, 3072
    s_addk_i32 s53, 3072
    buffer_load_dwordx4 v12, s[56:59], s53 offen sc1 lds
    s_addk_i32 m0, 3072
    s_addk_i32 s52, 3072
    buffer_load_dwordx4 v12, s[56:59], s52 offen sc1 lds
    s_addk_i32 m0, 3072
    s_addk_i32 s53, 3072
    buffer_load_dwordx4 v12, s[56:59], s53 offen sc1 lds
    s_barrier
    s_mov_b32 m0, s51
    s_addk_i32 s52, 3072
    buffer_load_dwordx4 v12, s[56:59], s52 offen sc1 lds
    s_addk_i32 m0, 3072
    s_addk_i32 s53, 3072
    buffer_load_dwordx4 v12, s[56:59], s53 offen sc1 lds
    s_cmp_eq_u32 0, 1
L_pad_l1:
    s_cbranch_scc1 L_ret
    s_addk_i32 m0, 3072
    s_addk_i32 s52, 3072
    buffer_load_dwordx4 v12, s[56:59], s52 offen sc1 lds
    s_addk_i32 m0, 3072
    s_addk_i32 s53, 3072
    buffer_load_dwordx4 v12, s[56:59], s53 offen sc1 lds
    s_waitcnt vmcnt(12)
    s_barrier
    s_addk_i32 m0, 3072
    s_addk_i32 s52, 3072
    buffer_load_dwordx4 v12, s[56:59], s52 offen sc1 lds
    s_addk_i32 m0, 3072
    s_addk_i32 s53, 3072
    buffer_load_dwordx4 v12, s[56:59], s53 offen sc1 lds
    s_barrier
    s_addk_i32 m0, 3072
    s_addk_i32 s52, 3072
    buffer_load_dwordx4 v12, s[56:59], s52 offen sc1 lds
    s_waitcnt vmcnt(11)
    s_barrier
    s_barrier
    s_waitcnt vmcnt(7)
    s_barrier
    s_addk_i32 m0, 3072
    s_mov_b32 s53, 316416
    buffer_load_dwordx4 v12, s[56:59], s53 offen sc1 lds
    s_addk_i32 m0, 3072
    s_mov_b32 s52, 294912
    buffer_load_dwordx4 v12, s[56:59], s52 offen sc1 lds
    s_addk_i32 m0, 3072
    s_addk_i32 s53, 3072
    buffer_load_dwordx4 v12, s[56:59], s53 offen sc1 lds
    s_addk_i32 m0, 3072
    s_addk_i32 s52, 3072
    buffer_load_dwordx4 v12, s[56:59], s52 offen sc1 lds
    s_barrier
    s_addk_i32 m0, 3072
    s_addk_i32 s53, 3072
    buffer_load_dwordx4 v12, s[56:59], s53 offen sc1 lds
    s_addk_i32 m0, 3072
    s_addk_i32 s52, 3072
    buffer_load_dwordx4 v12, s[56:59], s52 offen sc1 lds
    s_addk_i32 m0, 3072
    s_addk_i32 s53, 3072
    buffer_load_dwordx4 v12, s[56:59], s53 offen sc1 lds
    s_addk_i32 m0, 3072
    s_addk_i32 s52, 3072
    buffer_load_dwordx4 v12, s[56:59], s52 offen sc1 lds
    s_waitcnt vmcnt(9)
    s_barrier
    s_addk_i32 m0, 3072
    s_addk_i32 s53, 3072
    buffer_load_dwordx4 v12, s[56:59], s53 offen sc1 lds
    s_addk_i32 m0, 3072
    s_addk_i32 s52, 3072
    buffer_load_dwordx4 v12, s[56:59], s52 offen sc1 lds
    s_addk_i32 m0, 3072
    s_addk_i32 s53, 3072
    buffer_load_dwordx4 v12, s[56:59], s53 offen sc1 lds
    s_barrier
    s_addk_i32 m0, 3072
    s_addk_i32 s52, 3072
    buffer_load_dwordx4 v12, s[56:59], s52 offen sc1 lds
    s_addk_i32 m0, 3072
    s_addk_i32 s53, 3072
    buffer_load_dwordx4 v12, s[56:59], s53 offen sc1 lds
    s_addk_i32 m0, 3072
    s_addk_i32 s52, 3072
    buffer_load_dwordx4 v12, s[56:59], s52 offen sc1 lds
    s_addk_i32 m0, 3072
    s_addk_i32 s53, 3072
    buffer_load_dwordx4 v12, s[56:59], s53 offen sc1 lds
    s_waitcnt vmcnt(14)
    s_barrier
    s_waitcnt vmcnt(12)
    s_barrier
    s_waitcnt vmcnt(10)
    s_barrier
    s_waitcnt vmcnt(8)
    s_barrier
    s_waitcnt vmcnt(6)
    s_barrier
    s_mov_b32 m0, s51
    s_mov_b32 s52, 344064
    buffer_load_dwordx4 v12, s[56:59], s52 offen sc1 lds
    s_addk_i32 m0, 3072
    s_mov_b32 s53, 368640
    buffer_load_dwordx4 v12, s[56:59], s53 offen sc1 lds
    s_addk_i32 m0, 3072
    s_addk_i32 s52, 3072
    buffer_load_dwordx4 v12, s[56:59], s52 offen sc1 lds
    s_addk_i32 m0, 3072
    s_addk_i32 s53, 3072
    buffer_load_dwordx4 v12, s[56:59], s53 offen sc1 lds
    s_waitcnt vmcnt(8)
    s_barrier
    s_addk_i32 m0, 3072
    s_addk_i32 s52, 3072
    buffer_load_dwordx4 v12, s[56:59], s52 offen sc1 lds
    s_addk_i32 m0, 3072
    s_addk_i32 s53, 3072
    buffer_load_dwordx4 v12, s[56:59], s53 offen sc1 lds
    s_addk_i32 m0, 3072
    s_addk_i32 s52, 3072
    buffer_load_dwordx4 v12, s[56:59], s52 offen sc1 lds
    s_addk_i32 m0, 3072
    s_addk_i32 s53, 3072
    buffer_load_dwordx4 v12, s[56:59], s53 offen sc1 lds
    s_waitcnt vmcnt(8)
    s_barrier
    s_addk_i32 m0, 3072
    s_addk_i32 s52, 3072
    buffer_load_dwordx4 v12, s[56:59], s52 offen sc1 lds
    s_addk_i32 m0, 3072
    s_addk_i32 s53, 3072
    buffer_load_dwordx4 v12, s[56:59], s53 offen sc1 lds
    s_addk_i32 m0, 3072
    s_addk_i32 s52, 3072
    buffer_load_dwordx4 v12, s[56:59], s52 offen sc1 lds
    s_addk_i32 m0, 3072
    s_addk_i32 s53, 3072
    buffer_load_dwordx4 v12, s[56:59], s53 offen sc1 lds
    s_barrier
    s_addk_i32 m0, 3072
    s_addk_i32 s52, 3072
    buffer_load_dwordx4 v12, s[56:59], s52 offen sc1 lds
    s_addk_i32 m0, 3072
    s_addk_i32 s53, 3072
    buffer_load_dwordx4 v12, s[56:59], s53 offen sc1 lds
    s_barrier
    s_addk_i32 m0, 3072
    s_addk_i32 s52, 3072
    buffer_load_dwordx4 v12, s[56:59], s52 offen sc1 lds
    s_waitcnt vmcnt(11)
    s_barrier
    s_barrier
    s_waitcnt vmcnt(7)
    s_barrier
    s_addk_i32 m0, 3072
    s_mov_b32 s53, 414720
    buffer_load_dwordx4 v12, s[56:59], s53 offen sc1 lds
    s_addk_i32 m0, 3072
    s_mov_b32 s52, 393216
    buffer_load_dwordx4 v12, s[56:59], s52 offen sc1 lds
    s_addk_i32 m0, 3072
    s_addk_i32 s53, 3072
    buffer_load_dwordx4 v12, s[56:59], s53 offen sc1 lds
    s_addk_i32 m0, 3072
    s_addk_i32 s52, 3072
    buffer_load_dwordx4 v12, s[56:59], s52 offen sc1 lds
    s_barrier
    s_addk_i32 m0, 3072
    s_addk_i32 s53, 3072
    buffer_load_dwordx4 v12, s[56:59], s53 offen sc1 lds
    s_addk_i32 m0, 3072
    s_addk_i32 s52, 3072
    buffer_load_dwordx4 v12, s[56:59], s52 offen sc1 lds
    s_addk_i32 m0, 3072
    s_addk_i32 s53, 3072
    buffer_load_dwordx4 v12, s[56:59], s53 offen sc1 lds
    s_mov_b32 m0, s51
    s_addk_i32 s52, 3072
    buffer_load_dwordx4 v12, s[56:59], s52 offen sc1 lds
    s_waitcnt vmcnt(9)
    s_barrier
    s_addk_i32 m0, 3072
    s_addk_i32 s53, 3072
    buffer_load_dwordx4 v12, s[56:59], s53 offen sc1 lds
    s_addk_i32 m0, 3072
    s_addk_i32 s52, 3072
    buffer_load_dwordx4 v12, s[56:59], s52 offen sc1 lds
    s_addk_i32 m0, 3072
    s_addk_i32 s53, 3072
    buffer_load_dwordx4 v12, s[56:59], s53 offen sc1 lds
    s_barrier
    s_addk_i32 m0, 3072
    s_addk_i32 s52, 3072
    buffer_load_dwordx4 v12, s[56:59], s52 offen sc1 lds
    s_addk_i32 m0, 3072
    s_addk_i32 s53, 3072
    buffer_load_dwordx4 v12, s[56:59], s53 offen sc1 lds
    s_addk_i32 m0, 3072
    s_addk_i32 s52, 3072
    buffer_load_dwordx4 v12, s[56:59], s52 offen sc1 lds
    s_addk_i32 m0, 3072
    s_addk_i32 s53, 3072
    buffer_load_dwordx4 v12, s[56:59], s53 offen sc1 lds
    s_waitcnt vmcnt(14)
    s_barrier
    global_load_ushort v46, v5, s[8:9]
    global_load_ushort v47, v5, s[10:11]
    global_load_ushort v48, v5, s[12:13]
    buffer_load_dword v49, v52, s[28:31], 0 offen
    s_waitcnt vmcnt(14)
    s_barrier
    s_barrier
    s_barrier
    s_waitcnt vmcnt(4)
    s_barrier
    s_branch L_gather
.p2align 12
L_idle:
    v_lshlrev_b32 v1, 4, v9
    s_cmp_ge_u32 s40, 2
    s_cbranch_scc1 L_i_store
    s_lshl_b32 s45, s40, 3
    s_add_u32 s45, s45, s48
    s_mul_i32 s45, s45, 82944
    s_mul_i32 s46, s40, 9216
    s_getpc_b64 s[88:89]
L_pcref2:
    s_sub_u32 s88, s88, L_pcref2-standalone__self_sup_conv_stem_hubert__speech_kernel
    s_subb_u32 s89, s89, 0
    v_lshl_add_u32 v11, v0, 2, s48
    v_lshlrev_b32 v11, 7, v11
    v_min_u32 v11, L_codeend-standalone__self_sup_conv_stem_hubert__speech_kernel-4, v11
    v_mov_b32 v4, -1
    v_mov_b32 v5, -1
    v_mov_b32 v6, -1
    v_mov_b32 v7, -1
    s_waitcnt lgkmcnt(0)
    s_mov_b64 s[24:25], s[6:7]
    s_mov_b32 s26, 1285632
    s_mov_b32 s27, 0x20000
    s_mov_b64 s[32:33], s[18:19]
    s_mov_b32 s34, 135168
    s_mov_b32 s35, 0x20000
    s_add_u32 m0, s46, 0
    s_add_u32 s50, s45, 27648
    buffer_load_dwordx4 v1, s[24:27], s50 offen offset:0 lds
    buffer_load_dwordx4 v1, s[24:27], s50 offen offset:1024 lds
    buffer_load_dwordx4 v1, s[24:27], s50 offen offset:2048 lds
    buffer_load_dwordx4 v1, s[24:27], s50 offen offset:3072 lds
    s_addk_i32 m0, 4096
    s_addk_i32 s50, 4096
    buffer_load_dwordx4 v1, s[24:27], s50 offen offset:0 lds
    buffer_load_dwordx4 v1, s[24:27], s50 offen offset:1024 lds
    buffer_load_dwordx4 v1, s[24:27], s50 offen offset:2048 lds
    buffer_load_dwordx4 v1, s[24:27], s50 offen offset:3072 lds
    s_addk_i32 m0, 4096
    s_addk_i32 s50, 4096
    buffer_load_dwordx4 v1, s[24:27], s50 offen offset:0 lds
    s_add_u32 m0, s46, 18432
    s_add_u32 s50, s45, 359424
    buffer_load_dwordx4 v1, s[24:27], s50 offen offset:0 lds
    buffer_load_dwordx4 v1, s[24:27], s50 offen offset:1024 lds
    buffer_load_dwordx4 v1, s[24:27], s50 offen offset:2048 lds
    buffer_load_dwordx4 v1, s[24:27], s50 offen offset:3072 lds
    s_addk_i32 m0, 4096
    s_addk_i32 s50, 4096
    buffer_load_dwordx4 v1, s[24:27], s50 offen offset:0 lds
    buffer_load_dwordx4 v1, s[24:27], s50 offen offset:1024 lds
    buffer_load_dwordx4 v1, s[24:27], s50 offen offset:2048 lds
    buffer_load_dwordx4 v1, s[24:27], s50 offen offset:3072 lds
    s_addk_i32 m0, 4096
    s_addk_i32 s50, 4096
    buffer_load_dwordx4 v1, s[24:27], s50 offen offset:0 lds
    s_waitcnt vmcnt(9)
    s_barrier
    s_add_u32 m0, s46, 36864
    s_add_u32 s50, s45, 36864
    buffer_load_dwordx4 v1, s[24:27], s50 offen offset:0 lds
    buffer_load_dwordx4 v1, s[24:27], s50 offen offset:1024 lds
    buffer_load_dwordx4 v1, s[24:27], s50 offen offset:2048 lds
    buffer_load_dwordx4 v1, s[24:27], s50 offen offset:3072 lds
    s_addk_i32 m0, 4096
    s_addk_i32 s50, 4096
    buffer_load_dwordx4 v1, s[24:27], s50 offen offset:0 lds
    buffer_load_dwordx4 v1, s[24:27], s50 offen offset:1024 lds
    buffer_load_dwordx4 v1, s[24:27], s50 offen offset:2048 lds
    buffer_load_dwordx4 v1, s[24:27], s50 offen offset:3072 lds
    s_addk_i32 m0, 4096
    s_addk_i32 s50, 4096
    buffer_load_dwordx4 v1, s[24:27], s50 offen offset:0 lds
    s_waitcnt vmcnt(9)
    s_barrier
    s_add_u32 m0, s46, 55296
    s_add_u32 s50, s45, 368640
    buffer_load_dwordx4 v1, s[24:27], s50 offen offset:0 lds
    buffer_load_dwordx4 v1, s[24:27], s50 offen offset:1024 lds
    buffer_load_dwordx4 v1, s[24:27], s50 offen offset:2048 lds
    buffer_load_dwordx4 v1, s[24:27], s50 offen offset:3072 lds
    s_addk_i32 m0, 4096
    s_addk_i32 s50, 4096
    buffer_load_dwordx4 v1, s[24:27], s50 offen offset:0 lds
    buffer_load_dwordx4 v1, s[24:27], s50 offen offset:1024 lds
    buffer_load_dwordx4 v1, s[24:27], s50 offen offset:2048 lds
    buffer_load_dwordx4 v1, s[24:27], s50 offen offset:3072 lds
    s_addk_i32 m0, 4096
    s_addk_i32 s50, 4096
    buffer_load_dwordx4 v1, s[24:27], s50 offen offset:0 lds
    s_waitcnt vmcnt(9)
    s_barrier
    s_add_u32 m0, s46, 73728
    s_add_u32 s50, s45, 46080
    buffer_load_dwordx4 v1, s[24:27], s50 offen offset:0 lds
    buffer_load_dwordx4 v1, s[24:27], s50 offen offset:1024 lds
    buffer_load_dwordx4 v1, s[24:27], s50 offen offset:2048 lds
    buffer_load_dwordx4 v1, s[24:27], s50 offen offset:3072 lds
    s_addk_i32 m0, 4096
    s_addk_i32 s50, 4096
    buffer_load_dwordx4 v1, s[24:27], s50 offen offset:0 lds
    buffer_load_dwordx4 v1, s[24:27], s50 offen offset:1024 lds
    buffer_load_dwordx4 v1, s[24:27], s50 offen offset:2048 lds
    buffer_load_dwordx4 v1, s[24:27], s50 offen offset:3072 lds
    s_addk_i32 m0, 4096
    s_addk_i32 s50, 4096
    buffer_load_dwordx4 v1, s[24:27], s50 offen offset:0 lds
    s_waitcnt vmcnt(9)
    s_barrier
    s_add_u32 m0, s46, 92160
    s_add_u32 s50, s45, 377856
    buffer_load_dwordx4 v1, s[24:27], s50 offen offset:0 lds
    buffer_load_dwordx4 v1, s[24:27], s50 offen offset:1024 lds
    buffer_load_dwordx4 v1, s[24:27], s50 offen offset:2048 lds
    buffer_load_dwordx4 v1, s[24:27], s50 offen offset:3072 lds
    s_addk_i32 m0, 4096
    s_addk_i32 s50, 4096
    buffer_load_dwordx4 v1, s[24:27], s50 offen offset:0 lds
    buffer_load_dwordx4 v1, s[24:27], s50 offen offset:1024 lds
    buffer_load_dwordx4 v1, s[24:27], s50 offen offset:2048 lds
    buffer_load_dwordx4 v1, s[24:27], s50 offen offset:3072 lds
    s_addk_i32 m0, 4096
    s_addk_i32 s50, 4096
    buffer_load_dwordx4 v1, s[24:27], s50 offen offset:0 lds
    s_waitcnt vmcnt(9)
    s_barrier
    s_add_u32 m0, s46, 110592
    s_add_u32 s50, s45, 55296
    buffer_load_dwordx4 v1, s[24:27], s50 offen offset:0 lds
    buffer_load_dwordx4 v1, s[24:27], s50 offen offset:1024 lds
    buffer_load_dwordx4 v1, s[24:27], s50 offen offset:2048 lds
    buffer_load_dwordx4 v1, s[24:27], s50 offen offset:3072 lds
    s_addk_i32 m0, 4096
    s_addk_i32 s50, 4096
    buffer_load_dwordx4 v1, s[24:27], s50 offen offset:0 lds
    buffer_load_dwordx4 v1, s[24:27], s50 offen offset:1024 lds
    buffer_load_dwordx4 v1, s[24:27], s50 offen offset:2048 lds
    buffer_load_dwordx4 v1, s[24:27], s50 offen offset:3072 lds
    s_addk_i32 m0, 4096
    s_addk_i32 s50, 4096
    buffer_load_dwordx4 v1, s[24:27], s50 offen offset:0 lds
    s_waitcnt vmcnt(9)
    s_barrier
    s_add_u32 m0, s46, 129024
    s_add_u32 s50, s45, 387072
    buffer_load_dwordx4 v1, s[24:27], s50 offen offset:0 lds
    buffer_load_dwordx4 v1, s[24:27], s50 offen offset:1024 lds
    buffer_load_dwordx4 v1, s[24:27], s50 offen offset:2048 lds
    buffer_load_dwordx4 v1, s[24:27], s50 offen offset:3072 lds
    s_addk_i32 m0, 4096
    s_addk_i32 s50, 4096
    buffer_load_dwordx4 v1, s[24:27], s50 offen offset:0 lds
    buffer_load_dwordx4 v1, s[24:27], s50 offen offset:1024 lds
    buffer_load_dwordx4 v1, s[24:27], s50 offen offset:2048 lds
    buffer_load_dwordx4 v1, s[24:27], s50 offen offset:3072 lds
    s_addk_i32 m0, 4096
    s_addk_i32 s50, 4096
    buffer_load_dwordx4 v1, s[24:27], s50 offen offset:0 lds
    s_waitcnt vmcnt(9)
    s_barrier
    s_add_u32 m0, s46, 0
    s_add_u32 s50, s45, 64512
    buffer_load_dwordx4 v1, s[24:27], s50 offen offset:0 lds
    buffer_load_dwordx4 v1, s[24:27], s50 offen offset:1024 lds
    buffer_load_dwordx4 v1, s[24:27], s50 offen offset:2048 lds
    buffer_load_dwordx4 v1, s[24:27], s50 offen offset:3072 lds
    s_addk_i32 m0, 4096
    s_addk_i32 s50, 4096
    buffer_load_dwordx4 v1, s[24:27], s50 offen offset:0 lds
    buffer_load_dwordx4 v1, s[24:27], s50 offen offset:1024 lds
    buffer_load_dwordx4 v1, s[24:27], s50 offen offset:2048 lds
    buffer_load_dwordx4 v1, s[24:27], s50 offen offset:3072 lds
    s_addk_i32 m0, 4096
    s_addk_i32 s50, 4096
    buffer_load_dwordx4 v1, s[24:27], s50 offen offset:0 lds
    s_waitcnt vmcnt(9)
    s_barrier
    s_add_u32 m0, s46, 18432
    s_add_u32 s50, s45, 396288
    buffer_load_dwordx4 v1, s[24:27], s50 offen offset:0 lds
    buffer_load_dwordx4 v1, s[24:27], s50 offen offset:1024 lds
    buffer_load_dwordx4 v1, s[24:27], s50 offen offset:2048 lds
    buffer_load_dwordx4 v1, s[24:27], s50 offen offset:3072 lds
    s_addk_i32 m0, 4096
    s_addk_i32 s50, 4096
    buffer_load_dwordx4 v1, s[24:27], s50 offen offset:0 lds
    buffer_load_dwordx4 v1, s[24:27], s50 offen offset:1024 lds
    buffer_load_dwordx4 v1, s[24:27], s50 offen offset:2048 lds
    buffer_load_dwordx4 v1, s[24:27], s50 offen offset:3072 lds
    s_addk_i32 m0, 4096
    s_addk_i32 s50, 4096
    buffer_load_dwordx4 v1, s[24:27], s50 offen offset:0 lds
    s_waitcnt vmcnt(9)
    s_barrier
    s_add_u32 m0, s46, 36864
    s_add_u32 s50, s45, 73728
    buffer_load_dwordx4 v1, s[24:27], s50 offen offset:0 lds
    buffer_load_dwordx4 v1, s[24:27], s50 offen offset:1024 lds
    buffer_load_dwordx4 v1, s[24:27], s50 offen offset:2048 lds
    buffer_load_dwordx4 v1, s[24:27], s50 offen offset:3072 lds
    s_addk_i32 m0, 4096
    s_addk_i32 s50, 4096
    buffer_load_dwordx4 v1, s[24:27], s50 offen offset:0 lds
    buffer_load_dwordx4 v1, s[24:27], s50 offen offset:1024 lds
    buffer_load_dwordx4 v1, s[24:27], s50 offen offset:2048 lds
    buffer_load_dwordx4 v1, s[24:27], s50 offen offset:3072 lds
    s_addk_i32 m0, 4096
    s_addk_i32 s50, 4096
    buffer_load_dwordx4 v1, s[24:27], s50 offen offset:0 lds
    s_waitcnt vmcnt(9)
    s_barrier
    s_add_u32 m0, s46, 55296
    s_add_u32 s50, s45, 405504
    buffer_load_dwordx4 v1, s[24:27], s50 offen offset:0 lds
    buffer_load_dwordx4 v1, s[24:27], s50 offen offset:1024 lds
    buffer_load_dwordx4 v1, s[24:27], s50 offen offset:2048 lds
    buffer_load_dwordx4 v1, s[24:27], s50 offen offset:3072 lds
    s_addk_i32 m0, 4096
    s_addk_i32 s50, 4096
    buffer_load_dwordx4 v1, s[24:27], s50 offen offset:0 lds
    buffer_load_dwordx4 v1, s[24:27], s50 offen offset:1024 lds
    buffer_load_dwordx4 v1, s[24:27], s50 offen offset:2048 lds
    buffer_load_dwordx4 v1, s[24:27], s50 offen offset:3072 lds
    s_addk_i32 m0, 4096
    s_addk_i32 s50, 4096
    buffer_load_dwordx4 v1, s[24:27], s50 offen offset:0 lds
    s_waitcnt vmcnt(9)
    s_barrier
    s_waitcnt vmcnt(0)
    s_barrier
    s_lshl_b32 s3, s48, 1
    s_add_u32 s3, s3, s40
    s_mul_i32 s3, s3, 16896
    s_add_u32 s45, s3, 16896
L_i_fill:
    buffer_store_dwordx4 v[4:7], v1, s[32:35], s3 offen sc1
    s_addk_i32 s3, 1024
    s_cmp_lt_u32 s3, s45
    s_cbranch_scc1 L_i_fill
    s_barrier
    s_waitcnt vmcnt(0)
    s_barrier
    s_endpgm
L_i_store:
    s_cmp_ge_u32 s40, 5
    s_cselect_b32 s45, 1, 0
    s_cselect_b32 s46, 5, 2
    s_sub_u32 s46, s40, s46
    v_lshrrev_b32 v14, 4, v9
    v_bfe_u32 v15, v9, 2, 2
    v_lshl_add_u32 v14, v14, 3, v15
    v_and_b32 v15, 3, v9
    v_mad_u32_u24 v14, v14, 36, v15
    s_mul_i32 s3, s45, 9216
    s_mul_i32 s47, s46, 96
    s_add_u32 s3, s3, s47
    v_lshl_add_u32 v10, v14, 3, s3
    v_add_u32 v11, 55296, v10
    v_add_u32 v12, 110592, v10
    s_lshl_b32 s3, s45, 3
    s_add_u32 s3, s3, s48
    s_mul_i32 s3, s3, 3072
    s_mul_i32 s47, s46, 442368
    s_add_u32 s3, s3, s47
    v_add_u32 v1, s3, v1
    v_cmp_eq_u32 vcc, 128, v0
    s_lshl_b32 s3, s48, 2
    v_mov_b32 v14, s3
    v_mov_b32 v13, 4096
    v_cndmask_b32 v2, v13, v14, vcc
    s_mov_b32 s58, 1327104
    s_mov_b32 s59, 0x20000
    s_waitcnt lgkmcnt(0)
    s_add_u32 s56, s18, 262144
    s_addc_u32 s57, s19, 0
    s_mov_b64 s[36:37], s[16:17]
    s_mov_b32 s38, 256
    s_mov_b32 s39, 0x20000
    s_barrier
    ds_read_b64_tr_b16 v[16:17], v10 offset:0
    ds_read_b64_tr_b16 v[18:19], v10 offset:1152
    ds_read_b64_tr_b16 v[20:21], v10 offset:32
    ds_read_b64_tr_b16 v[22:23], v10 offset:1184
    ds_read_b64_tr_b16 v[24:25], v10 offset:64
    ds_read_b64_tr_b16 v[26:27], v10 offset:1216
    s_mov_b32 s52, 147456
    s_waitcnt lgkmcnt(4)
    buffer_store_dwordx4 v[16:19], v1, s[56:59], s52 offen offset:0 sc1
    s_waitcnt lgkmcnt(2)
    buffer_store_dwordx4 v[20:23], v1, s[56:59], s52 offen offset:1024 sc1
    s_waitcnt lgkmcnt(0)
    buffer_store_dwordx4 v[24:27], v1, s[56:59], s52 offen offset:2048 sc1
    s_barrier
    ds_read_b64_tr_b16 v[28:29], v10 offset:18432
    ds_read_b64_tr_b16 v[30:31], v10 offset:19584
    ds_read_b64_tr_b16 v[32:33], v10 offset:18464
    ds_read_b64_tr_b16 v[34:35], v10 offset:19616
    ds_read_b64_tr_b16 v[36:37], v10 offset:18496
    ds_read_b64_tr_b16 v[38:39], v10 offset:19648
    s_mov_b32 s52, 159744
    s_waitcnt lgkmcnt(4)
    buffer_store_dwordx4 v[28:31], v1, s[56:59], s52 offen offset:0 sc1
    s_waitcnt lgkmcnt(2)
    buffer_store_dwordx4 v[32:35], v1, s[56:59], s52 offen offset:1024 sc1
    s_waitcnt lgkmcnt(0)
    buffer_store_dwordx4 v[36:39], v1, s[56:59], s52 offen offset:2048 sc1
    s_barrier
    ds_read_b64_tr_b16 v[40:41], v10 offset:36864
    ds_read_b64_tr_b16 v[42:43], v10 offset:38016
    ds_read_b64_tr_b16 v[44:45], v10 offset:36896
    ds_read_b64_tr_b16 v[46:47], v10 offset:38048
    ds_read_b64_tr_b16 v[48:49], v10 offset:36928
    ds_read_b64_tr_b16 v[50:51], v10 offset:38080
    s_mov_b32 s52, 196608
    s_waitcnt lgkmcnt(4)
    buffer_store_dwordx4 v[40:43], v1, s[56:59], s52 offen offset:0 sc1
    s_waitcnt lgkmcnt(2)
    buffer_store_dwordx4 v[44:47], v1, s[56:59], s52 offen offset:1024 sc1
    s_waitcnt lgkmcnt(0)
    buffer_store_dwordx4 v[48:51], v1, s[56:59], s52 offen offset:2048 sc1
    s_waitcnt vmcnt(3)
    s_barrier
    buffer_store_dword v13, v2, s[36:39], 0 offen offset:0 sc1
    ds_read_b64_tr_b16 v[52:53], v11 offset:0
    ds_read_b64_tr_b16 v[54:55], v11 offset:1152
    ds_read_b64_tr_b16 v[56:57], v11 offset:32
    ds_read_b64_tr_b16 v[58:59], v11 offset:1184
    ds_read_b64_tr_b16 v[60:61], v11 offset:64
    ds_read_b64_tr_b16 v[62:63], v11 offset:1216
    s_mov_b32 s52, 208896
    s_waitcnt lgkmcnt(4)
    buffer_store_dwordx4 v[52:55], v1, s[56:59], s52 offen offset:0 sc1
    s_waitcnt lgkmcnt(2)
    buffer_store_dwordx4 v[56:59], v1, s[56:59], s52 offen offset:1024 sc1
    s_waitcnt lgkmcnt(0)
    buffer_store_dwordx4 v[60:63], v1, s[56:59], s52 offen offset:2048 sc1
    s_barrier
    ds_read_b64_tr_b16 v[64:65], v11 offset:18432
    ds_read_b64_tr_b16 v[66:67], v11 offset:19584
    ds_read_b64_tr_b16 v[68:69], v11 offset:18464
    ds_read_b64_tr_b16 v[70:71], v11 offset:19616
    ds_read_b64_tr_b16 v[72:73], v11 offset:18496
    ds_read_b64_tr_b16 v[74:75], v11 offset:19648
    s_mov_b32 s52, 245760
    s_waitcnt lgkmcnt(4)
    buffer_store_dwordx4 v[64:67], v1, s[56:59], s52 offen offset:0 sc1
    s_waitcnt lgkmcnt(2)
    buffer_store_dwordx4 v[68:71], v1, s[56:59], s52 offen offset:1024 sc1
    s_waitcnt lgkmcnt(0)
    buffer_store_dwordx4 v[72:75], v1, s[56:59], s52 offen offset:2048 sc1
    s_waitcnt vmcnt(3)
    s_barrier
    buffer_store_dword v13, v2, s[36:39], 0 offen offset:128 sc1
    ds_read_b64_tr_b16 v[76:77], v11 offset:36864
    ds_read_b64_tr_b16 v[78:79], v11 offset:38016
    ds_read_b64_tr_b16 v[80:81], v11 offset:36896
    ds_read_b64_tr_b16 v[82:83], v11 offset:38048
    ds_read_b64_tr_b16 v[84:85], v11 offset:36928
    ds_read_b64_tr_b16 v[86:87], v11 offset:38080
    s_mov_b32 s52, 258048
    s_waitcnt lgkmcnt(4)
    buffer_store_dwordx4 v[76:79], v1, s[56:59], s52 offen offset:0 sc1
    s_waitcnt lgkmcnt(2)
    buffer_store_dwordx4 v[80:83], v1, s[56:59], s52 offen offset:1024 sc1
    s_waitcnt lgkmcnt(0)
    buffer_store_dwordx4 v[84:87], v1, s[56:59], s52 offen offset:2048 sc1
    s_barrier
    ds_read_b64_tr_b16 v[88:89], v12 offset:0
    ds_read_b64_tr_b16 v[90:91], v12 offset:1152
    ds_read_b64_tr_b16 v[92:93], v12 offset:32
    ds_read_b64_tr_b16 v[94:95], v12 offset:1184
    ds_read_b64_tr_b16 v[96:97], v12 offset:64
    ds_read_b64_tr_b16 v[98:99], v12 offset:1216
    s_mov_b32 s52, 294912
    s_waitcnt lgkmcnt(4)
    buffer_store_dwordx4 v[88:91], v1, s[56:59], s52 offen offset:0 sc1
    s_waitcnt lgkmcnt(2)
    buffer_store_dwordx4 v[92:95], v1, s[56:59], s52 offen offset:1024 sc1
    s_waitcnt lgkmcnt(0)
    buffer_store_dwordx4 v[96:99], v1, s[56:59], s52 offen offset:2048 sc1
    s_waitcnt vmcnt(3)
    s_barrier
    buffer_store_dword v13, v2, s[36:39], 0 offen offset:16 sc1
    ds_read_b64_tr_b16 v[100:101], v12 offset:18432
    ds_read_b64_tr_b16 v[102:103], v12 offset:19584
    ds_read_b64_tr_b16 v[104:105], v12 offset:18464
    ds_read_b64_tr_b16 v[106:107], v12 offset:19616
    ds_read_b64_tr_b16 v[108:109], v12 offset:18496
    ds_read_b64_tr_b16 v[110:111], v12 offset:19648
    s_mov_b32 s52, 307200
    s_waitcnt lgkmcnt(4)
    buffer_store_dwordx4 v[100:103], v1, s[56:59], s52 offen offset:0 sc1
    s_waitcnt lgkmcnt(2)
    buffer_store_dwordx4 v[104:107], v1, s[56:59], s52 offen offset:1024 sc1
    s_waitcnt lgkmcnt(0)
    buffer_store_dwordx4 v[108:111], v1, s[56:59], s52 offen offset:2048 sc1
    s_barrier
    ds_read_b64_tr_b16 v[112:113], v10 offset:0
    ds_read_b64_tr_b16 v[114:115], v10 offset:1152
    ds_read_b64_tr_b16 v[116:117], v10 offset:32
    ds_read_b64_tr_b16 v[118:119], v10 offset:1184
    ds_read_b64_tr_b16 v[120:121], v10 offset:64
    ds_read_b64_tr_b16 v[122:123], v10 offset:1216
    s_mov_b32 s52, 344064
    s_waitcnt lgkmcnt(4)
    buffer_store_dwordx4 v[112:115], v1, s[56:59], s52 offen offset:0 sc1
    s_waitcnt lgkmcnt(2)
    buffer_store_dwordx4 v[116:119], v1, s[56:59], s52 offen offset:1024 sc1
    s_waitcnt lgkmcnt(0)
    buffer_store_dwordx4 v[120:123], v1, s[56:59], s52 offen offset:2048 sc1
    s_waitcnt vmcnt(3)
    s_barrier
    buffer_store_dword v13, v2, s[36:39], 0 offen offset:144 sc1
    ds_read_b64_tr_b16 v[124:125], v10 offset:18432
    ds_read_b64_tr_b16 v[126:127], v10 offset:19584
    ds_read_b64_tr_b16 v[128:129], v10 offset:18464
    ds_read_b64_tr_b16 v[130:131], v10 offset:19616
    ds_read_b64_tr_b16 v[132:133], v10 offset:18496
    ds_read_b64_tr_b16 v[134:135], v10 offset:19648
    s_mov_b32 s52, 356352
    s_waitcnt lgkmcnt(4)
    buffer_store_dwordx4 v[124:127], v1, s[56:59], s52 offen offset:0 sc1
    s_waitcnt lgkmcnt(2)
    buffer_store_dwordx4 v[128:131], v1, s[56:59], s52 offen offset:1024 sc1
    s_waitcnt lgkmcnt(0)
    buffer_store_dwordx4 v[132:135], v1, s[56:59], s52 offen offset:2048 sc1
    s_barrier
    ds_read_b64_tr_b16 v[136:137], v10 offset:36864
    ds_read_b64_tr_b16 v[138:139], v10 offset:38016
    ds_read_b64_tr_b16 v[140:141], v10 offset:36896
    ds_read_b64_tr_b16 v[142:143], v10 offset:38048
    ds_read_b64_tr_b16 v[144:145], v10 offset:36928
    ds_read_b64_tr_b16 v[146:147], v10 offset:38080
    s_mov_b32 s52, 393216
    s_waitcnt lgkmcnt(4)
    buffer_store_dwordx4 v[136:139], v1, s[56:59], s52 offen offset:0 sc1
    s_waitcnt lgkmcnt(2)
    buffer_store_dwordx4 v[140:143], v1, s[56:59], s52 offen offset:1024 sc1
    s_waitcnt lgkmcnt(0)
    buffer_store_dwordx4 v[144:147], v1, s[56:59], s52 offen offset:2048 sc1
    s_waitcnt vmcnt(3)
    s_barrier
    buffer_store_dword v13, v2, s[36:39], 0 offen offset:32 sc1
    ds_read_b64_tr_b16 v[148:149], v11 offset:0
    ds_read_b64_tr_b16 v[150:151], v11 offset:1152
    ds_read_b64_tr_b16 v[152:153], v11 offset:32
    ds_read_b64_tr_b16 v[154:155], v11 offset:1184
    ds_read_b64_tr_b16 v[156:157], v11 offset:64
    ds_read_b64_tr_b16 v[158:159], v11 offset:1216
    s_mov_b32 s52, 405504
    s_waitcnt lgkmcnt(4)
    buffer_store_dwordx4 v[148:151], v1, s[56:59], s52 offen offset:0 sc1
    s_waitcnt lgkmcnt(2)
    buffer_store_dwordx4 v[152:155], v1, s[56:59], s52 offen offset:1024 sc1
    s_waitcnt lgkmcnt(0)
    buffer_store_dwordx4 v[156:159], v1, s[56:59], s52 offen offset:2048 sc1
    s_barrier
    s_waitcnt vmcnt(0)
    s_barrier
    buffer_store_dword v13, v2, s[36:39], 0 offen offset:160 sc1
    s_endpgm
L_codeend:
    s_endpgm
.section .rodata,"a"
.p2align 6
.amdhsa_kernel standalone__self_sup_conv_stem_hubert__speech_kernel
  .amdhsa_next_free_vgpr 240
  .amdhsa_next_free_sgpr 102
  .amdhsa_accum_offset 240
  .amdhsa_group_segment_fixed_size 0
  .amdhsa_kernarg_size 64
  .amdhsa_user_sgpr_count 2
  .amdhsa_user_sgpr_kernarg_segment_ptr 1
  .amdhsa_system_sgpr_workgroup_id_x 1
  .amdhsa_float_denorm_mode_32 3
.end_amdhsa_kernel
```
